```python
import torch

def _softmax(x, axis=-1):
    return torch.softmax(x, dim=axis)

def _gelu(x):
    return torch.nn.functional.gelu(x, approximate='tanh')

def _silu(x):
    return torch.nn.functional.silu(x)

def _sigmoid(x):
    return torch.sigmoid(x)

def _layernorm(x, axis=-1, eps=1e-05):
    m = x.mean(dim=axis, keepdim=True)
    v = x.var(dim=axis, keepdim=True, unbiased=False)
    return (x - m) / torch.sqrt(v + eps)

def _scatter_add(tgt, idx, src, axis=0):
    return tgt.clone().index_add_(axis, idx, src)

def _segment_sum(src, seg, n):
    out = torch.zeros((n,) + src.shape[1:], dtype=src.dtype)
    return out.index_add_(0, seg, src)

def _pad(x, pw):
    flat = tuple((v for pair in reversed(pw) for v in pair))
    return torch.nn.functional.pad(x, flat)
kernel_name = 'adaLN_cond__ssm_conv_s4d__mixer_gmlp__prompt'

def setup_inputs():

    _w = lambda a: (lambda t: t.to(torch.bfloat16) if t.is_floating_point() else t)(torch.as_tensor(a))

    def _A_setup():
        Bsz, L, D, N = (1, 2048, 512, 128)
        return {'u': _w((lambda *s: torch.randn(*s, dtype=torch.bfloat16) * 0.05)(Bsz, L, D)), 'log_A_real': _w((lambda *s: torch.randn(*s, dtype=torch.bfloat16) * 3.2)(D, N) * 0.5), 'A_imag': _w((lambda *s: torch.randn(*s, dtype=torch.bfloat16) * 0.1)(D, N) * 3.14), 'C_real': _w((lambda *s: torch.randn(*s, dtype=torch.bfloat16) * 0.4)(D, N) / N ** 0.5), 'C_imag': _w((lambda *s: torch.randn(*s, dtype=torch.bfloat16) * 0.4)(D, N) / N ** 0.5), 'log_dt': _w((lambda *s: torch.randn(*s, dtype=torch.bfloat16) * 0.1)(D) * 0.5 - 4.0), 'D_skip': _w((lambda *s: torch.randn(*s, dtype=torch.bfloat16) * 0.1)(D))}
    _A_in = _A_setup()

    def _B_setup():
        B, S, D, F = (1, 2048, 512, 1792)
        Fh = F // 2
        return {'x': _w((lambda *s: torch.randn(*s, dtype=torch.bfloat16) * 0.05)(B, S, D)), 'w_in': _w((lambda *s: torch.randn(*s, dtype=torch.bfloat16) * 0.2)(D, 2 * Fh)), 'w_sp': _w(0.01 * (lambda *s: torch.randn(*s, dtype=torch.bfloat16) * 0.2)(S, S)), 'b_sp': _w(1.0 + 0.01 * (lambda *s: torch.randn(*s, dtype=torch.bfloat16) * 0.05)(S)), 'w_out': _w((lambda *s: torch.randn(*s, dtype=torch.bfloat16) * 0.05)(Fh, D))}
    _B_in = _B_setup()
    return {'A_u': _A_in['u'], 'A_log_A_real': _A_in['log_A_real'], 'A_A_imag': _A_in['A_imag'], 'A_C_real': _A_in['C_real'], 'A_C_imag': _A_in['C_imag'], 'A_log_dt': _A_in['log_dt'], 'A_D_skip': _A_in['D_skip'], 'B_x': _B_in['x'], 'B_w_in': _B_in['w_in'], 'B_w_sp': _B_in['w_sp'], 'B_b_sp': _B_in['b_sp'], 'B_w_out': _B_in['w_out'], 'c': _w((lambda *s: torch.randn(*s, dtype=torch.bfloat16) * 0.1)(1, 512) * 8.0), 'w_mod': _w((lambda *s: torch.randn(*s, dtype=torch.bfloat16) * 0.1)(512, 6 * 512) * 512 ** (-0.5) * 8.0)}

def reference(A_u, A_log_A_real, A_A_imag, A_C_real, A_C_imag, A_log_dt, A_D_skip, B_x, B_w_in, B_w_sp, B_b_sp, B_w_out, c, w_mod):

    def _A_ref(u, log_A_real, A_imag, C_real, C_imag, log_dt, D_skip):
        L = u.shape[1]
        dt = torch.exp(log_dt)
        A = -torch.exp(log_A_real) + 1j * A_imag
        C = (C_real + 1j * C_imag) * dt[:, None]
        pos = (lambda x, dt: x.to(dt))(torch.arange(L), log_dt.dtype)
        P = torch.exp((A * dt[:, None])[:, :, None] * pos[None, None, :])
        K = 2.0 * torch.einsum('dn,dnl->dl', C, P).real
        L2 = 2 * L
        u_t = (lambda x, *d: x.permute(*d))(u, 0, 2, 1)
        Kf = (lambda x, *a, **k: torch.fft.rfft(x.float(), *a, **k))(K, L2)
        Uf = (lambda x, *a, **k: torch.fft.rfft(x.float(), *a, **k))(u_t, L2)
        y = (lambda x, *a, **k: torch.fft.irfft(x, *a, **k).to(torch.bfloat16))(Uf * Kf[None, :, :], L2)[:, :, :L]
        y = (lambda x, *d: x.permute(*d))(y, 0, 2, 1)
        return y + u * D_skip[None, None, :]

    def _B_ref(x, w_in, w_sp, b_sp, w_out):
        B, S, D = x.shape
        F = w_in.shape[-1]
        Fh = F // 2
        z = _gelu(torch.einsum('bsd,df->bsf', x, w_in))
        z1 = z[..., :Fh].clone()
        z2 = _layernorm(z[..., Fh:], axis=-1)
        g = torch.einsum('ts,bsf->btf', w_sp, z2) + b_sp[None, :, None]
        return torch.einsum('bsf,fd->bsd', z1 * g, w_out)
    x = A_u
    mod = (_silu(c) @ w_mod).reshape(c.shape[0], 6, 1, -1)
    sa, ca, ga, sb, cb, gb = (mod[:, 0].clone(), mod[:, 1].clone(), mod[:, 2].clone(), mod[:, 3].clone(), mod[:, 4].clone(), mod[:, 5].clone())
    h = _layernorm(x, axis=-1) * (1 + ca) + sa
    x = x + ga * _A_ref(h, A_log_A_real, A_A_imag, A_C_real, A_C_imag, A_log_dt, A_D_skip)
    h = _layernorm(x, axis=-1) * (1 + cb) + sb
    x = x + gb * _B_ref(h, B_w_in, B_w_sp, B_b_sp, B_w_out)
    return x
```

```asm
; @launch grid=(256,1,1) block=(256,1,1) lds=163840
.amdgcn_target "amdgcn-amd-amdhsa--gfx950"
.text
.globl adaLN_cond__ssm_conv_s4d__mixer_gmlp__prompt_kernel
.p2align 8
.type adaLN_cond__ssm_conv_s4d__mixer_gmlp__prompt_kernel,@function
adaLN_cond__ssm_conv_s4d__mixer_gmlp__prompt_kernel:
    s_cmp_ge_u32 s2, 256
    s_cbranch_scc1 L_END
    s_load_dwordx2 s[8:9], s[0:1], 0
    s_load_dwordx8 s[32:39], s[0:1], 8
    s_getpc_b64 s[66:67]
L_pc:
    s_lshr_b32 s59, s2, 3
    v_lshrrev_b32 v4, 6, v0
    s_mul_i32 s65, s59, 1536
    v_and_b32 v1, 63, v0
    v_readfirstlane_b32 s50, v4
    v_mad_u32_u24 v26, v4, 3, v1
    v_lshl_add_u32 v26, v26, 7, s65
    v_min_u32 v26, L_END-L_pc, v26
    s_mov_b64 exec, 7
    global_load_dword v240, v26, s[66:67]
    s_mov_b64 exec, -1
    s_load_dwordx2 s[46:47], s[0:1], 96
    s_load_dwordx2 s[12:13], s[0:1], 104
    s_load_dwordx2 s[16:17], s[0:1], 64
    s_load_dwordx4 s[40:43], s[0:1], 40
    s_load_dwordx2 s[4:5], s[0:1], 128
    s_load_dwordx2 s[48:49], s[0:1], 120
    s_mov_b32 s10, 0x200000
    s_mov_b32 s11, 0x20000
    v_lshlrev_b32_e64 v4, 4, v1
    s_and_b32 s58, s2, 7
    s_mov_b32 s86, s2
    s_lshl_b32 s53, s86, 2
    s_add_u32 s53, s53, s50
    s_lshl_b32 s53, s53, 11
    s_lshl_b32 s64, s2, 2
    s_add_u32 s64, s64, s50
    s_lshl_b32 s64, s64, 7
    v_lshl_add_u32 v7, v1, 1, s64
    v_lshrrev_b32 v20, 3, v1
    v_and_b32 v21, 7, v1
    v_bfe_u32 v22, v20, 1, 1
    s_lshl_b32 s60, s50, 2
    s_and_b32 s60, s60, 4
    v_or_b32 v22, s60, v22
    v_xor_b32 v22, v22, v21
    v_lshlrev_b32_e64 v22, 4, v22
    v_lshl_add_u32 v22, v20, 10, v22
    v_xor_b32 v26, 32, v22
    s_lshr_b32 s60, s86, 3
    s_lshl_b32 s60, s60, 2
    s_add_u32 s60, s60, s50
    s_lshl_b32 s60, s60, 7
    s_and_b32 s61, s86, 7
    s_add_u32 s60, s60, s61
    s_lshl_b32 s60, s60, 7
    s_lshl_b32 s65, s50, 11
    s_xor_b32 s87, s50, 3
    s_lshl_b32 s87, s87, 8
    s_add_u32 s87, s87, s2
    s_cmp_lt_u32 s87, 8
    s_waitcnt lgkmcnt(0)
    s_cbranch_scc1 L_zero
L_zeroj:
    buffer_load_dwordx4 v[8:11], v4, s[8:11], s53 offen
    buffer_load_dwordx4 v[12:15], v4, s[8:11], s53 offen offset:1024
    global_load_ushort v16, v7, s[32:33]
    global_load_ushort v17, v7, s[34:35]
    global_load_ushort v18, v7, s[36:37]
    global_load_ushort v19, v7, s[38:39]
    s_mul_i32 s56, s2, 1366
    s_lshr_b32 s56, s56, 16
    s_mul_i32 s57, s56, 48
    s_sub_u32 s57, s2, s57
    s_min_u32 s62, s56, 3
    s_lshl_b32 s62, s62, 8
    v_and_b32 v5, 127, v0
    v_lshl_add_u32 v6, v5, 1, s62
    global_load_ushort v25, v6, s[46:47]
    s_mov_b32 s66, s65
    s_mov_b32 s6, 0x2000000
    s_mov_b32 s7, 0x20000
    s_lshr_b32 s90, s53, 8
    s_add_u32 s90, s90, 196608
    s_add_u32 s89, s90, 8192
    s_mul_i32 s88, s56, 12288
    s_lshl_b32 s68, s57, 8
    s_add_u32 s88, s88, s68
    s_lshl_b32 s68, s50, 6
    s_add_u32 s88, s88, s68
    s_add_u32 s88, s88, 212992
    v_mov_b32_e64 v27, s90
    v_writelane_b32 v27, s89, 1
    v_writelane_b32 v27, s88, 2
    s_mov_b32 s68, 0x2c0000
    v_writelane_b32 v27, s68, 3
    s_mov_b32 s68, 0x4d0000
    v_writelane_b32 v27, s68, 4
    s_mov_b64 exec, 31
    buffer_load_dword v240, v27, s[4:7], 0 offen
    global_load_ubyte v240, v1, s[48:49] offset:128
    s_mov_b64 exec, -1
    s_lshl_b32 s67, s2, 2
    s_load_dword s70, s[40:41], s67
    s_load_dword s71, s[42:43], s67
    s_mov_b32 s18, 0x1c0000
    s_mov_b32 s19, 0x20000
    v_and_b32 v2, 15, v0
    v_lshrrev_b32_e64 v3, 4, v1
    s_and_b32 s61, s50, 1
    s_lshl_b32 s61, s61, 3
    v_lshl_or_b32 v24, v3, 1, s61
    v_xor_b32 v24, v24, v2
    v_lshlrev_b32_e64 v24, 4, v24
    s_movk_i32 s61, 3584
    v_mad_u32_u24 v24, v3, s61, v24
    s_and_b32 s63, s2, 15
    s_lshl_b32 s63, s63, 2
    s_add_u32 s63, s63, s50
    s_mul_i32 s63, s63, 28672
    s_lshr_b32 s64, s2, 4
    s_lshl_b32 s64, s64, 8
    s_add_u32 s63, s63, s64
    s_cmp_ge_u32 s2, 224
    s_cselect_b32 s63, s18, s63
    s_add_u32 m0, s65, 147456
    s_add_u32 s64, s63, 14336
    buffer_load_dwordx4 v24, s[16:19], s63 offen lds
    s_add_u32 m0, s65, 148480
    s_nop 0
    buffer_load_dwordx4 v24, s[16:19], s64 offen lds
    s_cmp_ge_u32 s56, 4
    s_cbranch_scc1 L_1
    s_mov_b32 s14, 0x300000
    s_mov_b32 s15, 0x20000
    v_and_b32 v23, 6, v20
    v_xor_b32 v23, v23, v21
    v_lshlrev_b32 v23, 4, v23
    s_movk_i32 s61, 6144
    v_mad_u32_u24 v23, v20, s61, v23
    s_lshl_b32 s62, s56, 2
    s_add_u32 s62, s62, s50
    s_mul_i32 s62, s62, 196608
    s_lshl_b32 s63, s57, 7
    s_add_u32 s62, s62, s63
    s_lshl_b32 s65, s50, 12
    s_add_u32 m0, s65, 131072
    s_add_u32 s63, s62, 0
    buffer_load_dwordx4 v23, s[12:15], s63 offen lds
    s_add_u32 m0, s65, 132096
    s_add_u32 s63, s62, 49152
    buffer_load_dwordx4 v23, s[12:15], s63 offen lds
    s_add_u32 m0, s65, 133120
    s_add_u32 s63, s62, 98304
    buffer_load_dwordx4 v23, s[12:15], s63 offen lds
    s_add_u32 m0, s65, 134144
    s_add_u32 s63, s62, 147456
    buffer_load_dwordx4 v23, s[12:15], s63 offen lds
L_1:
    s_add_u32 m0, s66, 120320
    s_nop 0
    buffer_load_dwordx4 v22, s[8:11], s60 offen lds
    s_add_u32 m0, s66, 121344
    s_add_u32 s60, s60, 8192
    buffer_load_dwordx4 v26, s[8:11], s60 offen lds
    s_load_dwordx2 s[20:21], s[0:1], 72
    s_load_dwordx2 s[24:25], s[0:1], 88
    s_load_dwordx2 s[28:29], s[0:1], 112
    s_load_dwordx2 s[44:45], s[0:1], 80
    s_mov_b32 s6, 0x2000000
    s_mov_b32 s7, 0x20000
    s_cmp_eq_u32 s50, 3
    s_cbranch_scc0 L_3
    s_add_u32 s66, s2, 64
    s_lshl_b32 s66, s66, 7
    v_mov_b32 v28, 0
    v_mov_b32 v29, 0
    v_mov_b32 v30, 0
    v_mov_b32 v31, 0
    s_mov_b64 exec, 0xff
    buffer_store_dwordx4 v[28:31], v4, s[4:7], s66 offen sc1
    s_mov_b64 exec, -1
L_3:
    s_lshr_b32 s51, s58, 1
    s_lshl_b32 s51, s51, 3
    s_lshr_b32 s60, s59, 2
    s_add_u32 s51, s51, s60
    s_and_b32 s52, s58, 1
    s_lshl_b32 s52, s52, 2
    s_and_b32 s60, s59, 3
    s_add_u32 s52, s52, s60
    s_lshl_b32 s65, s51, 3
    s_add_u32 s65, s65, s52
    s_lshl_b32 s65, s65, 9
    s_lshl_b32 s66, s50, 17
    s_add_u32 s65, s65, s66
    s_add_u32 s65, s65, 262144
    v_lshlrev_b32 v28, 3, v1
    v_mov_b32 v26, -1
    v_mov_b32 v27, -1
    buffer_store_dwordx2 v[26:27], v28, s[4:7], s65 offen sc1
    s_mov_b32 s22, 0x800000
    s_mov_b32 s23, 0x20000
    s_mov_b32 s26, 0xe0000
    s_mov_b32 s27, 0x20000
    s_mov_b32 s30, 0x200000
    s_mov_b32 s31, 0x20000
    v_mov_b32 v52, 0
    v_mov_b32 v53, 0
    v_mov_b32 v54, 0
    v_mov_b32 v55, 0
    v_lshrrev_b32_e64 v50, 2, v0
    v_mul_u32_u24 v50, 4160, v50
    v_and_b32_e64 v51, 3, v0
    v_lshl_add_u32 v50, v51, 4, v50
    v_add_u32 v50, 73728, v50
    v_lshrrev_b32_e64 v56, 5, v1
    v_mul_u32_u24 v51, 4608, v56
    v_and_b32_e64 v57, 31, v1
    v_lshl_add_u32 v51, v57, 4, v51
    v_add_u32 v51, 102912, v51
    v_cmp_gt_u32 vcc, 32, v0
    ds_write_b128 v51, v[52:55]
    s_and_saveexec_b64 s[54:55], vcc
    ds_write_b128 v50, v[52:55]
    s_mov_b64 exec, -1
    v_lshrrev_b32 v204, 5, v5
    v_lshlrev_b32_e64 v204, 6, v204
    v_bfe_u32 v50, v5, 2, 2
    v_lshl_add_u32 v204, v50, 4, v204
    v_bfe_u32 v50, v5, 4, 1
    v_lshl_add_u32 v204, v50, 3, v204
    v_and_b32_e64 v50, 3, v5
    v_lshl_add_u32 v204, v50, 1, v204
    v_add_u32 v204, 155648, v204
    v_lshrrev_b32 v196, 2, v2
    v_and_b32 v197, 3, v2
    v_lshl_add_u32 v198, v197, 3, v196
    v_lshlrev_b32 v198, 7, v198
    v_lshrrev_b32 v50, 1, v196
    v_lshl_or_b32 v50, v197, 1, v50
    v_lshrrev_b32 v51, 1, v3
    s_lshl_b32 s58, s50, 1
    v_or_b32 v51, s58, v51
    v_xor_b32 v50, v50, v51
    v_lshl_add_u32 v198, v50, 4, v198
    v_and_b32_e64 v50, 1, v3
    v_lshl_add_u32 v198, v50, 3, v198
    v_add_u32 v198, 120320, v198
    v_lshlrev_b32 v199, 1, v3
    v_lshrrev_b32 v51, 1, v197
    v_add_u32 v199, v199, v51
    v_lshlrev_b32 v199, 13, v199
    v_and_b32_e64 v51, 1, v197
    v_lshl_add_u32 v199, v51, 4, v199
    v_lshl_add_u32 v199, v196, 5, v199
    s_and_b32 s91, s86, 7
    s_lshl_b32 s91, s91, 2
    s_add_u32 s91, s91, s50
    s_lshl_b32 s91, s91, 16
    s_lshr_b32 s58, s86, 3
    s_lshl_b32 s58, s58, 8
    s_add_u32 s91, s91, s58
    s_add_u32 s91, s91, 1048576
    v_lshl_or_b32 v50, v50, 2, v196
    v_xor_b32 v50, s50, v50
    v_lshl_add_u32 v200, v3, 3, v196
    v_lshlrev_b32_e64 v200, 8, v200
    v_lshl_add_u32 v200, v197, 3, v200
    v_lshl_add_u32 v200, v50, 5, v200
    v_add_u32 v200, 147456, v200
    v_xor_b32 v201, 0x80, v200
    s_lshr_b32 s92, s2, 4
    s_lshl_b32 s92, s92, 3
    s_add_u32 s92, s92, s50
    s_lshl_b32 s92, s92, 4
    s_and_b32 s58, s2, 15
    s_add_u32 s92, s92, s58
    s_lshl_b32 s92, s92, 10
    s_add_u32 s92, s92, 3145728
    s_cmp_ge_u32 s2, 224
    s_cselect_b32 s92, 33554432, s92
    s_add_u32 s93, s92, 65536
    v_lshl_add_u32 v202, v3, 2, v196
    v_bfe_u32 v50, v202, 1, 2
    v_xor_b32 v50, s50, v50
    v_lshlrev_b32_e64 v202, 7, v202
    v_lshl_add_u32 v202, v50, 5, v202
    v_lshl_add_u32 v202, v197, 3, v202
    v_add_u32 v202, 131072, v202
    v_lshlrev_b32_e64 v203, 4, v3
    v_add_u32 v203, 155648, v203
    v_lshlrev_b32 v205, 2, v1
    s_mul_i32 s94, s50, 17408
    s_mov_b32 m0, s94
    v_mov_b32_e64 v216, 0
    s_and_b32 s58, s2, 7
    s_lshl_b32 s68, s58, 7
    v_mul_u32_u24 v6, 1024, v1
    v_mov_b32_e64 v7, 1
    s_mov_b32 s66, 0x3f803f80
    s_cmp_ge_u32 s56, 4
    s_cbranch_scc0 L_4
    s_waitcnt vmcnt(7)
    s_branch L_5
L_4:
    s_waitcnt vmcnt(11)
L_5:
    s_cmp_lt_u32 s87, 8
    s_cbranch_scc0 L_6
    s_waitcnt lgkmcnt(0)
    s_mov_b64 exec, 1
    global_atomic_add v216, v7, s[48:49] sc1
    s_mov_b64 exec, -1
L_6:
    v_dot2_f32_bf16 v26, v8, s66, 0
    v_dot2_f32_bf16 v27, v8, v8, 0
    v_dot2_f32_bf16 v28, v12, s66, 0
    v_dot2_f32_bf16 v29, v12, v12, 0
    v_dot2_f32_bf16 v26, v9, s66, v26
    v_dot2_f32_bf16 v27, v9, v9, v27
    v_dot2_f32_bf16 v28, v13, s66, v28
    v_dot2_f32_bf16 v29, v13, v13, v29
    v_dot2_f32_bf16 v26, v10, s66, v26
    v_dot2_f32_bf16 v27, v10, v10, v27
    v_dot2_f32_bf16 v28, v14, s66, v28
    v_dot2_f32_bf16 v29, v14, v14, v29
    v_dot2_f32_bf16 v26, v11, s66, v26
    v_dot2_f32_bf16 v27, v11, v11, v27
    v_dot2_f32_bf16 v28, v15, s66, v28
    v_dot2_f32_bf16 v29, v15, v15, v29
    v_lshlrev_b32_e64 v25, 16, v25
    v_mul_f32 v30, 0xbfb8aa3b, v25
    v_exp_f32_e64 v30, v30
    v_add_f32_dpp v26, v26, v26 row_ror:8 row_mask:0xf bank_mask:0xf
    v_add_f32_dpp v27, v27, v27 row_ror:8 row_mask:0xf bank_mask:0xf
    v_add_f32_dpp v28, v28, v28 row_ror:8 row_mask:0xf bank_mask:0xf
    v_add_f32_dpp v29, v29, v29 row_ror:8 row_mask:0xf bank_mask:0xf
    v_add_f32_dpp v26, v26, v26 row_ror:4 row_mask:0xf bank_mask:0xf
    v_add_f32_dpp v27, v27, v27 row_ror:4 row_mask:0xf bank_mask:0xf
    v_add_f32_dpp v28, v28, v28 row_ror:4 row_mask:0xf bank_mask:0xf
    v_add_f32_dpp v29, v29, v29 row_ror:4 row_mask:0xf bank_mask:0xf
    v_add_f32_dpp v26, v26, v26 row_ror:2 row_mask:0xf bank_mask:0xf
    v_add_f32_dpp v27, v27, v27 row_ror:2 row_mask:0xf bank_mask:0xf
    v_add_f32_dpp v28, v28, v28 row_ror:2 row_mask:0xf bank_mask:0xf
    v_add_f32_dpp v29, v29, v29 row_ror:2 row_mask:0xf bank_mask:0xf
    v_add_f32_dpp v26, v26, v26 row_ror:1 row_mask:0xf bank_mask:0xf
    v_add_f32_dpp v27, v27, v27 row_ror:1 row_mask:0xf bank_mask:0xf
    v_add_f32_dpp v28, v28, v28 row_ror:1 row_mask:0xf bank_mask:0xf
    v_add_f32_dpp v29, v29, v29 row_ror:1 row_mask:0xf bank_mask:0xf
    v_add_f32 v30, 1.0, v30
    v_rcp_f32 v30, v30
    v_add_f32_dpp v26, v26, v26 row_bcast:15 row_mask:0xa bank_mask:0xf
    v_add_f32_dpp v27, v27, v27 row_bcast:15 row_mask:0xa bank_mask:0xf
    v_add_f32_dpp v28, v28, v28 row_bcast:15 row_mask:0xa bank_mask:0xf
    v_add_f32_dpp v29, v29, v29 row_bcast:15 row_mask:0xa bank_mask:0xf
    v_mul_f32_e64 v30, v25, v30
    s_mov_b32 s66, 0x3b000000
    v_add_f32_dpp v26, v26, v26 row_bcast:31 row_mask:0xc bank_mask:0xf
    v_add_f32_dpp v27, v27, v27 row_bcast:31 row_mask:0xc bank_mask:0xf
    v_add_f32_dpp v28, v28, v28 row_bcast:31 row_mask:0xc bank_mask:0xf
    v_add_f32_dpp v29, v29, v29 row_bcast:31 row_mask:0xc bank_mask:0xf
    v_cvt_pk_bf16_f32 v30, v30, v30
    ds_write_b16 v204, v30
    v_pk_mul_f32 v[26:27], v[26:27], s[66:67] op_sel_hi:[1,0]
    v_pk_mul_f32 v[28:29], v[28:29], s[66:67] op_sel_hi:[1,0]
    v_fma_f32 v27, -v26, v26, v27
    v_fma_f32 v29, -v28, v28, v29
    v_max_f32 v27, 0, v27
    v_max_f32 v29, 0, v29
    v_add_f32 v27, 0x3727c5ac, v27
    v_add_f32 v29, 0x3727c5ac, v29
    v_rsq_f32 v32, v27
    v_rsq_f32_e64 v33, v29
    s_mov_b32 exec_lo, 0
    s_mov_b32 exec_hi, 0x80000000
    v_mul_f32 v34, -v26, v32
    v_mul_f32 v35, -v28, v33
    buffer_store_dwordx2 v[32:33], v216, s[4:7], s90 offen sc1
    buffer_store_dwordx2 v[34:35], v216, s[4:7], s89 offen sc1
    s_mov_b64 exec, -1
    s_waitcnt lgkmcnt(0)
    s_lshr_b32 s53, s50, 1
    s_lshl_b32 s53, s53, 4
    s_lshr_b32 s54, s70, s53
    s_lshl_b32 s54, s54, 16
    v_mov_b32 v48, 0x3fb8aa3b
    v_mul_f32 v48, s54, v48
    v_exp_f32 v48, v48
    v_lshlrev_b32_e64 v16, 16, v16
    v_mul_f32 v16, 0x3fb8aa3b, v16
    v_exp_f32_e64 v16, v16
    v_cvt_pk_bf16_f32 v48, v48, v48
    v_lshlrev_b32 v17, 16, v17
    v_lshlrev_b32 v48, 16, v48
    v_cvt_pk_bf16_f32 v16, v16, v16
    v_lshlrev_b32 v18, 16, v18
    v_lshlrev_b32 v16, 16, v16
    v_lshlrev_b32 v19, 16, v19
    v_mul_f32 v16, v16, v48
    v_mul_f32_e64 v17, v17, v48
    v_mul_f32 v46, 0xbfb8aa3b, v16
    v_mul_f32 v47, 0.15915494, v17
    v_add_f32 v48, v48, v48
    v_mul_f32 v30, v18, v48
    v_mul_f32 v31, v19, v48
    v_mul_f32 v36, 0x41000000, v47
    v_mul_f32_e64 v38, 1.0, v47
    v_mul_f32 v40, 0x43800000, v47
    v_mul_f32 v37, 0x41000000, v46
    v_mul_f32_e64 v39, 1.0, v46
    v_mul_f32 v41, 0x43800000, v46
    v_fract_f32 v36, v36
    v_fract_f32 v38, v38
    v_fract_f32 v40, v40
    v_exp_f32 v37, v37
    v_exp_f32 v39, v39
    v_exp_f32 v41, v41
    v_cos_f32 v26, v36
    v_cos_f32 v20, v38
    v_cos_f32 v28, v40
    v_sin_f32 v27, v36
    v_sin_f32 v21, v38
    v_sin_f32 v29, v40
    v_pk_mul_f32 v[26:27], v[26:27], v[36:37] op_sel:[0,1] op_sel_hi:[1,1]
    v_pk_mul_f32 v[20:21], v[20:21], v[38:39] op_sel:[0,1] op_sel_hi:[1,1]
    v_pk_mul_f32 v[28:29], v[28:29], v[40:41] op_sel:[0,1] op_sel_hi:[1,1]
    v_cvt_pk_bf16_f32 v40, v30, -v31
    v_mov_b32 v44, 0x3f80
    v_pk_mul_f32 v[36:37], v[20:21], v[20:21] op_sel_hi:[0,1]
    v_cvt_pk_bf16_f32 v42, v26, v27
    v_pk_fma_f32 v[22:23], v[20:21], v[20:21], v[36:37] op_sel:[1,1,0] op_sel_hi:[1,0,1] neg_lo:[0,1,0]
    v_pk_mul_f32 v[38:39], v[26:27], v[26:27] op_sel_hi:[0,1]
    ds_write_addtid_b32 v40 offset:0
    ds_write_addtid_b32 v44 offset:8704
    v_pk_mul_f32 v[36:37], v[30:31], v[20:21] op_sel_hi:[0,1]
    v_pk_fma_f32 v[34:35], v[26:27], v[26:27], v[38:39] op_sel:[1,1,0] op_sel_hi:[1,0,1] neg_lo:[0,1,0]
    v_pk_fma_f32 v[32:33], v[30:31], v[20:21], v[36:37] op_sel:[1,1,0] op_sel_hi:[1,0,1] neg_lo:[0,1,0]
    ds_write_addtid_b32 v42 offset:8976
    v_cvt_pk_bf16_f32 v41, v32, -v33
    v_cvt_pk_bf16_f32 v43, v34, v35
    v_pk_mul_f32 v[36:37], v[22:23], v[22:23] op_sel_hi:[0,1]
    v_pk_mul_f32 v[38:39], v[34:35], v[26:27] op_sel_hi:[0,1]
    v_pk_fma_f32 v[24:25], v[22:23], v[22:23], v[36:37] op_sel:[1,1,0] op_sel_hi:[1,0,1] neg_lo:[0,1,0]
    v_pk_fma_f32 v[34:35], v[34:35], v[26:27], v[38:39] op_sel:[1,1,0] op_sel_hi:[1,0,1] neg_lo:[0,1,0]
    ds_write_addtid_b32 v41 offset:272
    ds_write_addtid_b32 v43 offset:9248
    v_pk_mul_f32 v[36:37], v[32:33], v[20:21] op_sel_hi:[0,1]
    v_cvt_pk_bf16_f32 v42, v34, v35
    v_pk_fma_f32 v[32:33], v[32:33], v[20:21], v[36:37] op_sel:[1,1,0] op_sel_hi:[1,0,1] neg_lo:[0,1,0]
    v_pk_mul_f32 v[38:39], v[34:35], v[26:27] op_sel_hi:[0,1]
    v_cvt_pk_bf16_f32 v40, v32, -v33
    v_pk_fma_f32 v[34:35], v[34:35], v[26:27], v[38:39] op_sel:[1,1,0] op_sel_hi:[1,0,1] neg_lo:[0,1,0]
    v_pk_mul_f32 v[36:37], v[32:33], v[20:21] op_sel_hi:[0,1]
    ds_write_addtid_b32 v42 offset:9520
    v_pk_fma_f32 v[32:33], v[32:33], v[20:21], v[36:37] op_sel:[1,1,0] op_sel_hi:[1,0,1] neg_lo:[0,1,0]
    v_cvt_pk_bf16_f32 v43, v34, v35
    ds_write_addtid_b32 v40 offset:544
    v_pk_mul_f32 v[38:39], v[34:35], v[26:27] op_sel_hi:[0,1]
    v_cvt_pk_bf16_f32 v41, v32, -v33
    v_pk_fma_f32 v[34:35], v[34:35], v[26:27], v[38:39] op_sel:[1,1,0] op_sel_hi:[1,0,1] neg_lo:[0,1,0]
    v_pk_mul_f32 v[36:37], v[32:33], v[20:21] op_sel_hi:[0,1]
    ds_write_addtid_b32 v43 offset:9792
    v_pk_fma_f32 v[32:33], v[32:33], v[20:21], v[36:37] op_sel:[1,1,0] op_sel_hi:[1,0,1] neg_lo:[0,1,0]
    v_cvt_pk_bf16_f32 v42, v34, v35
    ds_write_addtid_b32 v41 offset:816
    v_pk_mul_f32 v[38:39], v[34:35], v[26:27] op_sel_hi:[0,1]
    v_cvt_pk_bf16_f32 v40, v32, -v33
    v_pk_fma_f32 v[34:35], v[34:35], v[26:27], v[38:39] op_sel:[1,1,0] op_sel_hi:[1,0,1] neg_lo:[0,1,0]
    v_pk_mul_f32 v[36:37], v[32:33], v[20:21] op_sel_hi:[0,1]
    ds_write_addtid_b32 v42 offset:10064
    v_pk_fma_f32 v[32:33], v[32:33], v[20:21], v[36:37] op_sel:[1,1,0] op_sel_hi:[1,0,1] neg_lo:[0,1,0]
    v_cvt_pk_bf16_f32 v43, v34, v35
    ds_write_addtid_b32 v40 offset:1088
    v_pk_mul_f32 v[38:39], v[34:35], v[26:27] op_sel_hi:[0,1]
    v_cvt_pk_bf16_f32 v41, v32, -v33
    v_pk_fma_f32 v[34:35], v[34:35], v[26:27], v[38:39] op_sel:[1,1,0] op_sel_hi:[1,0,1] neg_lo:[0,1,0]
    v_pk_mul_f32 v[36:37], v[32:33], v[20:21] op_sel_hi:[0,1]
    ds_write_addtid_b32 v43 offset:10336
    v_pk_fma_f32 v[32:33], v[32:33], v[20:21], v[36:37] op_sel:[1,1,0] op_sel_hi:[1,0,1] neg_lo:[0,1,0]
    v_cvt_pk_bf16_f32 v42, v34, v35
    ds_write_addtid_b32 v41 offset:1360
    v_pk_mul_f32 v[38:39], v[34:35], v[26:27] op_sel_hi:[0,1]
    v_cvt_pk_bf16_f32 v40, v32, -v33
    v_pk_fma_f32 v[34:35], v[34:35], v[26:27], v[38:39] op_sel:[1,1,0] op_sel_hi:[1,0,1] neg_lo:[0,1,0]
    v_pk_mul_f32 v[36:37], v[32:33], v[20:21] op_sel_hi:[0,1]
    ds_write_addtid_b32 v42 offset:10608
    v_pk_fma_f32 v[32:33], v[32:33], v[20:21], v[36:37] op_sel:[1,1,0] op_sel_hi:[1,0,1] neg_lo:[0,1,0]
    v_cvt_pk_bf16_f32 v43, v34, v35
    ds_write_addtid_b32 v40 offset:1632
    v_pk_mul_f32 v[38:39], v[34:35], v[26:27] op_sel_hi:[0,1]
    v_cvt_pk_bf16_f32 v41, v32, -v33
    v_pk_fma_f32 v[34:35], v[34:35], v[26:27], v[38:39] op_sel:[1,1,0] op_sel_hi:[1,0,1] neg_lo:[0,1,0]
    v_pk_mul_f32 v[36:37], v[30:31], v[28:29] op_sel_hi:[0,1]
    ds_write_addtid_b32 v43 offset:10880
    v_pk_fma_f32 v[30:31], v[30:31], v[28:29], v[36:37] op_sel:[1,1,0] op_sel_hi:[1,0,1] neg_lo:[0,1,0]
    v_cvt_pk_bf16_f32 v42, v34, v35
    ds_write_addtid_b32 v41 offset:1904
    v_pk_mul_f32 v[38:39], v[34:35], v[26:27] op_sel_hi:[0,1]
    v_cvt_pk_bf16_f32 v40, v30, -v31
    v_pk_fma_f32 v[34:35], v[34:35], v[26:27], v[38:39] op_sel:[1,1,0] op_sel_hi:[1,0,1] neg_lo:[0,1,0]
    v_pk_mul_f32 v[36:37], v[30:31], v[22:23] op_sel_hi:[0,1]
    ds_write_addtid_b32 v42 offset:11152
    v_pk_fma_f32 v[32:33], v[30:31], v[22:23], v[36:37] op_sel:[1,1,0] op_sel_hi:[1,0,1] neg_lo:[0,1,0]
    v_cvt_pk_bf16_f32 v43, v34, v35
    ds_write_addtid_b32 v40 offset:2176
    v_pk_mul_f32 v[38:39], v[34:35], v[26:27] op_sel_hi:[0,1]
    v_cvt_pk_bf16_f32 v41, v32, -v33
    v_pk_fma_f32 v[34:35], v[34:35], v[26:27], v[38:39] op_sel:[1,1,0] op_sel_hi:[1,0,1] neg_lo:[0,1,0]
    v_pk_mul_f32 v[36:37], v[32:33], v[22:23] op_sel_hi:[0,1]
    ds_write_addtid_b32 v43 offset:11424
    v_pk_fma_f32 v[32:33], v[32:33], v[22:23], v[36:37] op_sel:[1,1,0] op_sel_hi:[1,0,1] neg_lo:[0,1,0]
    v_cvt_pk_bf16_f32 v42, v34, v35
    ds_write_addtid_b32 v41 offset:2448
    v_pk_mul_f32 v[38:39], v[34:35], v[26:27] op_sel_hi:[0,1]
    v_cvt_pk_bf16_f32 v40, v32, -v33
    v_pk_fma_f32 v[34:35], v[34:35], v[26:27], v[38:39] op_sel:[1,1,0] op_sel_hi:[1,0,1] neg_lo:[0,1,0]
    v_pk_mul_f32 v[36:37], v[32:33], v[22:23] op_sel_hi:[0,1]
    ds_write_addtid_b32 v42 offset:11696
    v_pk_fma_f32 v[32:33], v[32:33], v[22:23], v[36:37] op_sel:[1,1,0] op_sel_hi:[1,0,1] neg_lo:[0,1,0]
    v_cvt_pk_bf16_f32 v43, v34, v35
    ds_write_addtid_b32 v40 offset:2720
    v_pk_mul_f32 v[38:39], v[34:35], v[26:27] op_sel_hi:[0,1]
    ds_write_addtid_b32 v40 offset:3264
    v_pk_fma_f32 v[34:35], v[34:35], v[26:27], v[38:39] op_sel:[1,1,0] op_sel_hi:[1,0,1] neg_lo:[0,1,0]
    v_cvt_pk_bf16_f32 v41, v32, -v33
    ds_write_addtid_b32 v43 offset:11968
    v_pk_mul_f32 v[36:37], v[32:33], v[22:23] op_sel_hi:[0,1]
    v_cvt_pk_bf16_f32 v42, v34, v35
    v_pk_fma_f32 v[32:33], v[32:33], v[22:23], v[36:37] op_sel:[1,1,0] op_sel_hi:[1,0,1] neg_lo:[0,1,0]
    v_pk_mul_f32 v[38:39], v[34:35], v[26:27] op_sel_hi:[0,1]
    ds_write_addtid_b32 v41 offset:3536
    v_pk_fma_f32 v[34:35], v[34:35], v[26:27], v[38:39] op_sel:[1,1,0] op_sel_hi:[1,0,1] neg_lo:[0,1,0]
    v_cvt_pk_bf16_f32 v40, v32, -v33
    ds_write_addtid_b32 v42 offset:12240
    v_pk_mul_f32 v[36:37], v[30:31], v[28:29] op_sel_hi:[0,1]
    v_cvt_pk_bf16_f32 v43, v34, v35
    v_pk_fma_f32 v[30:31], v[30:31], v[28:29], v[36:37] op_sel:[1,1,0] op_sel_hi:[1,0,1] neg_lo:[0,1,0]
    v_pk_mul_f32 v[38:39], v[34:35], v[26:27] op_sel_hi:[0,1]
    ds_write_addtid_b32 v40 offset:3808
    v_pk_fma_f32 v[34:35], v[34:35], v[26:27], v[38:39] op_sel:[1,1,0] op_sel_hi:[1,0,1] neg_lo:[0,1,0]
    v_cvt_pk_bf16_f32 v41, v30, -v31
    ds_write_addtid_b32 v43 offset:12512
    v_pk_mul_f32 v[36:37], v[30:31], v[24:25] op_sel_hi:[0,1]
    v_cvt_pk_bf16_f32 v42, v34, v35
    v_pk_fma_f32 v[32:33], v[30:31], v[24:25], v[36:37] op_sel:[1,1,0] op_sel_hi:[1,0,1] neg_lo:[0,1,0]
    v_pk_mul_f32 v[38:39], v[34:35], v[26:27] op_sel_hi:[0,1]
    ds_write_addtid_b32 v41 offset:4352
    v_pk_fma_f32 v[34:35], v[34:35], v[26:27], v[38:39] op_sel:[1,1,0] op_sel_hi:[1,0,1] neg_lo:[0,1,0]
    v_cvt_pk_bf16_f32 v40, v32, -v33
    ds_write_addtid_b32 v42 offset:12784
    v_pk_mul_f32 v[36:37], v[32:33], v[24:25] op_sel_hi:[0,1]
    v_cvt_pk_bf16_f32 v43, v34, v35
    v_pk_fma_f32 v[32:33], v[32:33], v[24:25], v[36:37] op_sel:[1,1,0] op_sel_hi:[1,0,1] neg_lo:[0,1,0]
    v_pk_mul_f32 v[38:39], v[34:35], v[26:27] op_sel_hi:[0,1]
    ds_write_addtid_b32 v40 offset:4624
    v_pk_fma_f32 v[34:35], v[34:35], v[26:27], v[38:39] op_sel:[1,1,0] op_sel_hi:[1,0,1] neg_lo:[0,1,0]
    v_cvt_pk_bf16_f32 v41, v32, -v33
    ds_write_addtid_b32 v43 offset:13056
    v_pk_mul_f32 v[36:37], v[30:31], v[28:29] op_sel_hi:[0,1]
    v_cvt_pk_bf16_f32 v42, v34, v35
    v_pk_fma_f32 v[30:31], v[30:31], v[28:29], v[36:37] op_sel:[1,1,0] op_sel_hi:[1,0,1] neg_lo:[0,1,0]
    v_pk_mul_f32 v[38:39], v[34:35], v[26:27] op_sel_hi:[0,1]
    ds_write_addtid_b32 v41 offset:4896
    v_pk_fma_f32 v[34:35], v[34:35], v[26:27], v[38:39] op_sel:[1,1,0] op_sel_hi:[1,0,1] neg_lo:[0,1,0]
    v_cvt_pk_bf16_f32 v40, v30, -v31
    ds_write_addtid_b32 v42 offset:13328
    s_waitcnt vmcnt(2) lgkmcnt(0)
    s_barrier
    ds_read_b64_tr_b16 v[180:181], v198 offset:0
    ds_read_b64_tr_b16 v[182:183], v198 offset:512
    ds_read_b64_tr_b16 v[184:185], v198 offset:4096
    ds_read_b64_tr_b16 v[186:187], v198 offset:4608
    ds_read_b64_tr_b16 v[188:189], v200 offset:0
    ds_read_b64_tr_b16 v[190:191], v200 offset:1024
    ds_read_b64_tr_b16 v[192:193], v201 offset:0
    ds_read_b64_tr_b16 v[194:195], v201 offset:1024
    s_cmp_ge_u32 s56, 4
    s_cbranch_scc1 L_7
    ds_read_b128 v[144:147], v203 offset:0
    ds_read_b64_tr_b16 v[148:149], v202 offset:0
    ds_read_b64_tr_b16 v[150:151], v202 offset:2048
    ds_read_b128 v[152:155], v203 offset:64
    ds_read_b64_tr_b16 v[156:157], v202 offset:4096
    ds_read_b64_tr_b16 v[158:159], v202 offset:6144
    ds_read_b128 v[160:163], v203 offset:128
    ds_read_b64_tr_b16 v[164:165], v202 offset:8192
    ds_read_b64_tr_b16 v[166:167], v202 offset:10240
    ds_read_b128 v[168:171], v203 offset:192
    ds_read_b64_tr_b16 v[172:173], v202 offset:12288
    ds_read_b64_tr_b16 v[174:175], v202 offset:14336
    s_waitcnt lgkmcnt(9)
    v_mfma_f32_16x16x32_bf16 v[176:179], v[144:147], v[148:151], 0
    buffer_store_dwordx4 v[180:183], v199, s[4:7], s91 offen sc1
    s_waitcnt lgkmcnt(6)
    v_mfma_f32_16x16x32_bf16 v[176:179], v[152:155], v[156:159], v[176:179]
    buffer_store_dwordx4 v[184:187], v199, s[4:7], s91 offen offset:128 sc1
    s_waitcnt lgkmcnt(3)
    v_mfma_f32_16x16x32_bf16 v[176:179], v[160:163], v[164:167], v[176:179]
    buffer_store_dwordx4 v[188:191], v4, s[4:7], s92 offen sc1
    s_waitcnt lgkmcnt(0)
    v_mfma_f32_16x16x32_bf16 v[176:179], v[168:171], v[172:175], v[176:179]
    buffer_store_dwordx4 v[192:195], v4, s[4:7], s93 offen sc1
    s_nop 5
    s_mov_b64 exec, 0xffff
    buffer_store_dword v176, v205, s[4:7], s88 offen sc1
    s_mov_b64 exec, -1
    s_branch L_7j
L_7:
    s_waitcnt lgkmcnt(0)
    buffer_store_dwordx4 v[180:183], v199, s[4:7], s91 offen sc1
    buffer_store_dwordx4 v[184:187], v199, s[4:7], s91 offen offset:128 sc1
    buffer_store_dwordx4 v[188:191], v4, s[4:7], s92 offen sc1
    buffer_store_dwordx4 v[192:195], v4, s[4:7], s93 offen sc1
L_7j:
    s_cmp_eq_u32 s50, 0
    s_cbranch_scc0 L_8
    global_load_dword v217, v216, s[48:49] sc1
L_8:
    v_mul_u32_u24 v207, 272, v57
    v_lshl_add_u32 v207, v56, 4, v207
    v_add_u32_e64 v207, s94, v207
    v_lshl_add_u32 v208, v1, 5, s94
    s_xor_b32 s58, s50, 1
    s_mul_i32 s58, s58, 17408
    v_lshl_add_u32 v209, v1, 5, s58
    s_lshr_b32 s58, s50, 1
    s_mul_i32 s58, s58, 16640
    s_add_u32 s58, s58, 69632
    v_lshlrev_b32_e64 v57, 4, v57
    v_lshl_add_u32 v210, v56, 3, v57
    v_sub_u32_e64 v210, s58, v210
    v_lshl_add_u32 v211, v56, 9, v57
    v_sub_u32_e64 v211, s58, v211
    v_lshl_add_u32 v212, v56, 10, v57
    s_add_u32 s58, s58, 1520
    v_sub_u32 v212, s58, v212
    v_lshlrev_b32 v213, 4, v0
    v_add_u32 v213, 69632, v213
    s_lshl_b32 s69, s51, 18
    s_lshl_b32 s58, s52, 13
    s_add_u32 s69, s69, s58
    s_lshl_b32 s58, s50, 11
    s_add_u32 s69, s69, s58
    v_lshlrev_b32 v214, 7, v1
    v_pk_mul_f32 v[36:37], v[30:31], v[24:25] op_sel_hi:[0,1]
    v_cvt_pk_bf16_f32 v43, v34, v35
    v_pk_fma_f32 v[32:33], v[30:31], v[24:25], v[36:37] op_sel:[1,1,0] op_sel_hi:[1,0,1] neg_lo:[0,1,0]
    v_pk_mul_f32 v[38:39], v[34:35], v[26:27] op_sel_hi:[0,1]
    ds_write_addtid_b32 v40 offset:5440
    v_pk_fma_f32 v[34:35], v[34:35], v[26:27], v[38:39] op_sel:[1,1,0] op_sel_hi:[1,0,1] neg_lo:[0,1,0]
    v_cvt_pk_bf16_f32 v41, v32, -v33
    ds_write_addtid_b32 v43 offset:13600
    v_pk_mul_f32 v[36:37], v[32:33], v[24:25] op_sel_hi:[0,1]
    v_cvt_pk_bf16_f32 v42, v34, v35
    v_pk_fma_f32 v[32:33], v[32:33], v[24:25], v[36:37] op_sel:[1,1,0] op_sel_hi:[1,0,1] neg_lo:[0,1,0]
    v_pk_mul_f32 v[38:39], v[34:35], v[26:27] op_sel_hi:[0,1]
    ds_write_addtid_b32 v41 offset:5712
    v_pk_fma_f32 v[34:35], v[34:35], v[26:27], v[38:39] op_sel:[1,1,0] op_sel_hi:[1,0,1] neg_lo:[0,1,0]
    v_cvt_pk_bf16_f32 v40, v32, -v33
    ds_write_addtid_b32 v42 offset:13872
    v_pk_mul_f32 v[36:37], v[30:31], v[28:29] op_sel_hi:[0,1]
    v_cvt_pk_bf16_f32 v43, v34, v35
    v_pk_fma_f32 v[30:31], v[30:31], v[28:29], v[36:37] op_sel:[1,1,0] op_sel_hi:[1,0,1] neg_lo:[0,1,0]
    v_pk_mul_f32 v[38:39], v[34:35], v[26:27] op_sel_hi:[0,1]
    ds_write_addtid_b32 v40 offset:5984
    v_pk_fma_f32 v[34:35], v[34:35], v[26:27], v[38:39] op_sel:[1,1,0] op_sel_hi:[1,0,1] neg_lo:[0,1,0]
    v_cvt_pk_bf16_f32 v41, v30, -v31
    ds_write_addtid_b32 v43 offset:14144
    v_pk_mul_f32 v[36:37], v[30:31], v[26:27] op_sel_hi:[0,1]
    v_cvt_pk_bf16_f32 v42, v34, v35
    v_pk_fma_f32 v[32:33], v[30:31], v[26:27], v[36:37] op_sel:[1,1,0] op_sel_hi:[1,0,1] neg_lo:[0,1,0]
    v_pk_mul_f32 v[38:39], v[34:35], v[26:27] op_sel_hi:[0,1]
    ds_write_addtid_b32 v41 offset:6528
    v_pk_fma_f32 v[34:35], v[34:35], v[26:27], v[38:39] op_sel:[1,1,0] op_sel_hi:[1,0,1] neg_lo:[0,1,0]
    v_cvt_pk_bf16_f32 v40, v32, -v33
    ds_write_addtid_b32 v42 offset:14416
    v_pk_mul_f32 v[36:37], v[30:31], v[28:29] op_sel_hi:[0,1]
    v_cvt_pk_bf16_f32 v43, v34, v35
    v_pk_fma_f32 v[30:31], v[30:31], v[28:29], v[36:37] op_sel:[1,1,0] op_sel_hi:[1,0,1] neg_lo:[0,1,0]
    v_pk_mul_f32 v[38:39], v[34:35], v[26:27] op_sel_hi:[0,1]
    ds_write_addtid_b32 v40 offset:6800
    v_pk_fma_f32 v[34:35], v[34:35], v[26:27], v[38:39] op_sel:[1,1,0] op_sel_hi:[1,0,1] neg_lo:[0,1,0]
    v_cvt_pk_bf16_f32 v41, v30, -v31
    ds_write_addtid_b32 v43 offset:14688
    v_pk_mul_f32 v[36:37], v[30:31], v[26:27] op_sel_hi:[0,1]
    v_cvt_pk_bf16_f32 v42, v34, v35
    v_pk_fma_f32 v[32:33], v[30:31], v[26:27], v[36:37] op_sel:[1,1,0] op_sel_hi:[1,0,1] neg_lo:[0,1,0]
    v_pk_mul_f32 v[38:39], v[34:35], v[26:27] op_sel_hi:[0,1]
    ds_write_addtid_b32 v41 offset:7072
    v_pk_fma_f32 v[34:35], v[34:35], v[26:27], v[38:39] op_sel:[1,1,0] op_sel_hi:[1,0,1] neg_lo:[0,1,0]
    v_cvt_pk_bf16_f32 v40, v32, -v33
    ds_write_addtid_b32 v42 offset:14960
    v_pk_mul_f32 v[36:37], v[30:31], v[28:29] op_sel_hi:[0,1]
    v_cvt_pk_bf16_f32 v43, v34, v35
    v_pk_fma_f32 v[30:31], v[30:31], v[28:29], v[36:37] op_sel:[1,1,0] op_sel_hi:[1,0,1] neg_lo:[0,1,0]
    v_pk_mul_f32 v[38:39], v[34:35], v[26:27] op_sel_hi:[0,1]
    ds_write_addtid_b32 v40 offset:7344
    v_pk_fma_f32 v[34:35], v[34:35], v[26:27], v[38:39] op_sel:[1,1,0] op_sel_hi:[1,0,1] neg_lo:[0,1,0]
    v_cvt_pk_bf16_f32 v41, v30, -v31
    ds_write_addtid_b32 v43 offset:15232
    v_pk_mul_f32 v[36:37], v[30:31], v[26:27] op_sel_hi:[0,1]
    v_cvt_pk_bf16_f32 v42, v34, v35
    v_pk_fma_f32 v[32:33], v[30:31], v[26:27], v[36:37] op_sel:[1,1,0] op_sel_hi:[1,0,1] neg_lo:[0,1,0]
    v_pk_mul_f32 v[38:39], v[34:35], v[26:27] op_sel_hi:[0,1]
    ds_write_addtid_b32 v41 offset:7616
    v_pk_fma_f32 v[34:35], v[34:35], v[26:27], v[38:39] op_sel:[1,1,0] op_sel_hi:[1,0,1] neg_lo:[0,1,0]
    v_cvt_pk_bf16_f32 v40, v32, -v33
    ds_write_addtid_b32 v42 offset:15504
    v_pk_mul_f32 v[36:37], v[30:31], v[28:29] op_sel_hi:[0,1]
    v_cvt_pk_bf16_f32 v43, v34, v35
    v_pk_fma_f32 v[30:31], v[30:31], v[28:29], v[36:37] op_sel:[1,1,0] op_sel_hi:[1,0,1] neg_lo:[0,1,0]
    v_pk_mul_f32 v[38:39], v[34:35], v[26:27] op_sel_hi:[0,1]
    ds_write_addtid_b32 v40 offset:7888
    v_pk_fma_f32 v[34:35], v[34:35], v[26:27], v[38:39] op_sel:[1,1,0] op_sel_hi:[1,0,1] neg_lo:[0,1,0]
    v_cvt_pk_bf16_f32 v41, v30, -v31
    ds_write_addtid_b32 v43 offset:15776
    v_pk_mul_f32 v[36:37], v[30:31], v[26:27] op_sel_hi:[0,1]
    v_cvt_pk_bf16_f32 v42, v34, v35
    v_pk_fma_f32 v[32:33], v[30:31], v[26:27], v[36:37] op_sel:[1,1,0] op_sel_hi:[1,0,1] neg_lo:[0,1,0]
    v_pk_mul_f32 v[38:39], v[34:35], v[26:27] op_sel_hi:[0,1]
    ds_write_addtid_b32 v41 offset:8160
    v_pk_fma_f32 v[34:35], v[34:35], v[26:27], v[38:39] op_sel:[1,1,0] op_sel_hi:[1,0,1] neg_lo:[0,1,0]
    v_cvt_pk_bf16_f32 v40, v32, -v33
    ds_write_addtid_b32 v42 offset:16048
    ds_write_addtid_b32 v40 offset:8432
    v_cvt_pk_bf16_f32 v43, v34, v35
    v_pk_mul_f32 v[38:39], v[34:35], v[26:27] op_sel_hi:[0,1]
    v_pk_fma_f32 v[34:35], v[34:35], v[26:27], v[38:39] op_sel:[1,1,0] op_sel_hi:[1,0,1] neg_lo:[0,1,0]
    ds_write_addtid_b32 v43 offset:16320
    v_cvt_pk_bf16_f32 v42, v34, v35
    v_pk_mul_f32 v[38:39], v[34:35], v[26:27] op_sel_hi:[0,1]
    v_pk_fma_f32 v[34:35], v[34:35], v[26:27], v[38:39] op_sel:[1,1,0] op_sel_hi:[1,0,1] neg_lo:[0,1,0]
    ds_write_addtid_b32 v42 offset:16592
    v_cvt_pk_bf16_f32 v43, v34, v35
    v_pk_mul_f32 v[38:39], v[34:35], v[26:27] op_sel_hi:[0,1]
    v_pk_fma_f32 v[34:35], v[34:35], v[26:27], v[38:39] op_sel:[1,1,0] op_sel_hi:[1,0,1] neg_lo:[0,1,0]
    ds_write_addtid_b32 v43 offset:16864
    v_cvt_pk_bf16_f32 v42, v34, v35
    ds_write_addtid_b32 v42 offset:17136
    s_cmp_eq_u32 s50, 0
    s_cbranch_scc0 L_dbgok
    s_mov_b64 exec, 0x1
    s_mov_b32 s54, 0
    s_waitcnt vmcnt(0)
    s_branch poll_9c
poll_9:
    global_load_dword v217, v216, s[48:49] sc1
    s_waitcnt vmcnt(0)
poll_9c:
    v_cmp_gt_u32 vcc, 8, v217
    s_add_u32 s54, s54, 1
    s_cbranch_vccz pollx_10
    s_sleep 8
    s_cmp_lt_u32 s54, 0x40000
    s_cbranch_scc1 poll_9
pollx_10:
    s_mov_b64 exec, -1
L_dbgok:
    s_waitcnt vmcnt(0) lgkmcnt(0)
    s_barrier
    s_cmp_eq_u32 s50, 0
    s_cbranch_scc0 sig_11
    s_mov_b64 exec, 0xff
    buffer_atomic_add v7, v6, s[4:7], s68 offen sc1
    s_mov_b64 exec, -1
sig_11:
    s_mul_i32 s72, s51, 28672
    s_mul_i32 s73, s50, 7168
    s_add_u32 s72, s72, s73
    s_lshl_b32 s73, s52, 7
    s_add_u32 s72, s72, s73
    v_lshlrev_b32 v222, 10, v1
    s_lshl_b32 s73, s51, 7
    v_mov_b32 v223, s73
    s_mov_b64 exec, 1
    global_load_dword v240, v223, s[44:45]
    s_mov_b64 exec, 0x7f
    buffer_load_dword v240, v222, s[24:27], s72 offen
    s_mov_b64 exec, -1
    v_lshlrev_b32 v222, 21, v1
    s_mov_b32 s72, 0x6f0000
    s_lshl_b32 s73, s51, 16
    s_mov_b64 exec, 0x3f
    buffer_load_dword v240, v222, s[4:7], s72 offen
    s_mov_b64 exec, 1
    buffer_load_dword v240, v222, s[28:31], s73 offen
    s_mov_b64 exec, -1
    s_add_u32 s85, s69, 0
    s_mov_b64 exec, 0xffff
    buffer_load_dword v240, v214, s[20:23], s85 offen
    s_mov_b64 exec, -1
    s_add_u32 s85, s69, 65536
    s_mov_b64 exec, 0xffff
    buffer_load_dword v240, v214, s[20:23], s85 offen
    s_mov_b64 exec, -1
    s_waitcnt lgkmcnt(0)
    ds_read_b128 v[64:67], v207 offset:0
    ds_read_b128 v[68:71], v207 offset:8704
    ds_read_b128 v[72:75], v207 offset:32
    ds_read_b128 v[76:79], v207 offset:8736
    ds_read_b128 v[80:83], v207 offset:64
    ds_read_b128 v[84:87], v207 offset:8768
    ds_read_b128 v[88:91], v207 offset:96
    ds_read_b128 v[92:95], v207 offset:8800
    ds_read_b128 v[96:99], v207 offset:128
    ds_read_b128 v[100:103], v207 offset:8832
    ds_read_b128 v[104:107], v207 offset:160
    ds_read_b128 v[108:111], v207 offset:8864
    ds_read_b128 v[112:115], v207 offset:192
    ds_read_b128 v[116:119], v207 offset:8896
    ds_read_b128 v[120:123], v207 offset:224
    ds_read_b128 v[124:127], v207 offset:8928
    s_waitcnt lgkmcnt(14)
    v_mfma_f32_32x32x16_bf16 v[128:143], v[64:67], v[68:71], 0
    s_waitcnt lgkmcnt(12)
    v_mfma_f32_32x32x16_bf16 v[128:143], v[72:75], v[76:79], v[128:143]
    s_waitcnt lgkmcnt(10)
    v_mfma_f32_32x32x16_bf16 v[128:143], v[80:83], v[84:87], v[128:143]
    s_waitcnt lgkmcnt(8)
    v_mfma_f32_32x32x16_bf16 v[128:143], v[88:91], v[92:95], v[128:143]
    s_waitcnt lgkmcnt(6)
    v_mfma_f32_32x32x16_bf16 v[128:143], v[96:99], v[100:103], v[128:143]
    s_waitcnt lgkmcnt(4)
    v_mfma_f32_32x32x16_bf16 v[128:143], v[104:107], v[108:111], v[128:143]
    s_waitcnt lgkmcnt(2)
    v_mfma_f32_32x32x16_bf16 v[128:143], v[112:115], v[116:119], v[128:143]
    s_waitcnt lgkmcnt(0)
    v_mfma_f32_32x32x16_bf16 v[128:143], v[120:123], v[124:127], v[128:143]
    v_lshlrev_b32 v252, 5, v0
    v_and_b32_e64 v253, 3, v1
    v_mul_u32_u24 v253, 3072, v253
    v_bfe_u32 v220, v1, 2, 1
    v_add_u32_e64 v253, v253, v220
    v_bfe_u32 v220, v1, 3, 2
    v_add_u32 v221, 1, v220
    v_lshrrev_b32 v221, 2, v221
    v_add_u32_e64 v220, v220, v221
    v_lshl_add_u32 v253, v220, 9, v253
    v_lshlrev_b32_e64 v253, 2, v253
    s_lshl_b32 s40, s2, 3
    s_add_u32 s40, s40, 212992
    s_lshl_b32 s41, s2, 13
    s_add_u32 s41, s41, 1048576
    s_mov_b32 s42, 196608
    s_mov_b32 s43, 204800
    s_and_b32 s60, s2, 7
    s_lshl_b32 s60, s60, 10
    v_lshl_add_u32 v250, v1, 7, s60
    v_mov_b32 v251, v4
    s_bitcmp1_b32 s50, 0
    s_cbranch_scc1 L_12w
    ds_write_b128 v208, v[136:139]
    ds_write_b128 v208, v[140:143] offset:16
    s_branch L_13w
L_12w:
    ds_write_b128 v208, v[128:131]
    ds_write_b128 v208, v[132:135] offset:16
L_13w:
    s_waitcnt lgkmcnt(0)
    s_barrier
    ds_read_b128 v[64:67], v209
    ds_read_b128 v[68:71], v209 offset:16
    v_and_b32_e64 v57, 1, v1
    v_cmp_eq_u32 vcc, 1, v57
    s_bitcmp1_b32 s50, 0
    s_waitcnt lgkmcnt(0)
    s_cbranch_scc1 L_12
    v_pk_add_f32 v[64:65], v[64:65], v[128:129]
    v_pk_add_f32 v[66:67], v[66:67], v[130:131]
    v_pk_add_f32 v[68:69], v[68:69], v[132:133]
    v_pk_add_f32 v[70:71], v[70:71], v[134:135]
    v_cvt_pk_bf16_f32 v72, v67, v66
    v_cvt_pk_bf16_f32 v73, v65, v64
    v_cvt_pk_bf16_f32 v74, v70, v69
    v_cvt_pk_bf16_f32 v75, v68, v68
    ds_write_b64 v210, v[72:73] offset:4088
    ds_write_b64 v210, v[74:75] offset:3576
    s_branch L_13
L_12:
    s_nop 0
    v_pk_add_f32 v[64:65], v[64:65], v[136:137]
    v_pk_add_f32 v[66:67], v[66:67], v[138:139]
    v_pk_add_f32 v[68:69], v[68:69], v[140:141]
    v_pk_add_f32 v[70:71], v[70:71], v[142:143]
    v_cvt_pk_bf16_f32 v72, v66, v66
    v_cvt_pk_bf16_f32 v73, v65, v65
    v_cvt_pk_bf16_f32 v74, v65, v64
    v_cvt_pk_bf16_f32 v75, v64, v64
    v_cndmask_b32 v64, v68, v69, vcc
    v_cndmask_b32 v65, v70, v71, vcc
    ds_write_b128 v211, v[72:75] offset:3056
    v_cvt_pk_bf16_f32 v76, v69, v69
    v_cvt_pk_bf16_f32 v77, v69, v64
    v_cvt_pk_bf16_f32 v78, v68, v68
    v_cvt_pk_bf16_f32 v79, v68, v68
    v_cvt_pk_bf16_f32 v80, v71, v71
    v_cvt_pk_bf16_f32 v81, v71, v65
    v_cvt_pk_bf16_f32 v82, v70, v70
    v_cvt_pk_bf16_f32 v83, v70, v70
    ds_write_b128 v212, v[76:79] offset:512
    ds_write_b128 v212, v[80:83]
L_13:
    s_waitcnt lgkmcnt(0)
    s_barrier
    ds_read_b128 v[64:67], v213 offset:0
    ds_read_b64 v[68:69], v213 offset:16
    ds_read_b128 v[88:91], v213 offset:16640
    ds_read_b64 v[92:93], v213 offset:16656
    s_lshr_b32 s60, s50, 1
    s_and_b32 s61, s50, 1
    v_and_b32 v241, 3, v2
    v_sub_u32 v241, 3, v241
    v_mul_u32_u24 v241, 4160, v241
    v_lshrrev_b32 v219, 2, v2
    v_lshlrev_b32 v219, 3, v219
    v_sub_u32_e64 v241, v241, v219
    v_lshl_add_u32 v241, v3, 4, v241
    s_mul_i32 s62, s60, 16640
    s_lshl_b32 s63, s61, 8
    s_sub_u32 s62, s62, s63
    s_add_u32 s62, s62, 69912
    v_add_u32 v241, s62, v241
    s_waitcnt lgkmcnt(2)
    v_alignbit_b32 v72, v65, v64, 16
    v_alignbit_b32 v73, v66, v65, 16
    v_alignbit_b32 v74, v67, v66, 16
    v_alignbit_b32 v75, v68, v67, 16
    ds_write_b128 v213, v[72:75] offset:4160
    v_mov_b32 v76, v65
    v_mov_b32 v77, v66
    v_mov_b32 v78, v67
    v_mov_b32 v79, v68
    ds_write_b128 v213, v[76:79] offset:8320
    v_alignbit_b32 v80, v66, v65, 16
    v_alignbit_b32 v81, v67, v66, 16
    v_alignbit_b32 v82, v68, v67, 16
    v_alignbit_b32 v83, v69, v68, 16
    ds_write_b128 v213, v[80:83] offset:12480
    s_waitcnt lgkmcnt(3)
    s_nop 0
    v_alignbit_b32 v96, v89, v88, 16
    v_alignbit_b32 v97, v90, v89, 16
    v_alignbit_b32 v98, v91, v90, 16
    v_alignbit_b32 v99, v92, v91, 16
    ds_write_b128 v213, v[96:99] offset:20800
    v_mov_b32 v100, v89
    v_mov_b32 v101, v90
    v_mov_b32 v102, v91
    v_mov_b32 v103, v92
    ds_write_b128 v213, v[100:103] offset:24960
    v_alignbit_b32 v104, v90, v89, 16
    v_alignbit_b32 v105, v91, v90, 16
    v_alignbit_b32 v106, v92, v91, 16
    v_alignbit_b32 v107, v93, v92, 16
    ds_write_b128 v213, v[104:107] offset:29120
    s_waitcnt lgkmcnt(0)
    s_barrier
    ds_read_b64 v[128:129], v241 offset:3776
    ds_read_b64 v[130:131], v241 offset:3784
    ds_read_b64 v[132:133], v241 offset:3264
    ds_read_b64 v[134:135], v241 offset:3272
    ds_read_b64 v[136:137], v241 offset:2752
    ds_read_b64 v[138:139], v241 offset:2760
    ds_read_b64 v[140:141], v241 offset:2240
    ds_read_b64 v[142:143], v241 offset:2248
    ds_read_b64 v[144:145], v241 offset:1728
    ds_read_b64 v[146:147], v241 offset:1736
    ds_read_b64 v[148:149], v241 offset:1216
    ds_read_b64 v[150:151], v241 offset:1224
    ds_read_b64 v[152:153], v241 offset:704
    ds_read_b64 v[154:155], v241 offset:712
    ds_read_b64 v[156:157], v241 offset:192
    ds_read_b64 v[158:159], v241 offset:200
    s_cmp_eq_u32 s50, 0
    s_cbranch_scc0 L_14
    s_mov_b64 exec, 0xff
    s_mov_b32 s54, 0
poll_15:
    buffer_load_dword v63, v250, s[4:7], 0 offen sc1
    s_waitcnt vmcnt(0)
poll_15c:
    v_cmp_gt_u32 vcc, 32, v63
    s_add_u32 s54, s54, 1
    s_cbranch_vccz pollx_16
    s_sleep 4
    s_cmp_lt_u32 s54, 0x40000
    s_cbranch_scc1 poll_15
pollx_16:
    s_mov_b64 exec, -1
L_14:
    s_barrier
    buffer_load_dword v62, v253, s[4:7], s40 offen sc1
    buffer_load_dwordx4 v[64:67], v252, s[4:7], s41 offen sc1
    buffer_load_dwordx4 v[68:71], v252, s[4:7], s41 offen offset:16 sc1
    buffer_load_dwordx4 v[72:75], v252, s[4:7], s42 offen sc1
    buffer_load_dwordx4 v[80:83], v252, s[4:7], s43 offen sc1
    buffer_load_dwordx4 v[76:79], v252, s[4:7], s42 offen offset:16 sc1
    buffer_load_dwordx4 v[84:87], v252, s[4:7], s43 offen offset:16 sc1
    v_lshlrev_b32 v219, 5, v2
    v_lshl_add_u32 v242, v3, 4, v219
    s_mul_i32 s62, s60, 4608
    s_sub_u32 s64, s62, s63
    s_add_u32 s64, s64, 103200
    v_add_u32 v242, s64, v242
    v_lshl_add_u32 v219, v3, 3, v219
    s_lshl_b32 s63, s61, 11
    s_add_u32 s64, s62, s63
    s_add_u32 s64, s64, 103424
    v_add_u32 v243, s64, v219
    s_lshl_b32 s62, s60, 12
    s_add_u32 s64, s62, s63
    s_add_u32 s64, s64, 112128
    v_add_u32 v244, s64, v219
    v_lshlrev_b32_e64 v245, 4, v0
    v_add_u32 v246, 112128, v245
    v_add_u32 v245, 103424, v245
    v_add_u32 v247, s94, v251
    s_xor_b32 s62, s50, 1
    s_mul_i32 s62, s62, 17408
    v_add_u32 v248, s62, v251
    s_lshl_b32 s62, s2, 1
    s_add_u32 s62, s62, s60
    s_bfe_u32 s63, s62, 0x10003
    s_bfe_u32 s64, s62, 0x10001
    s_lshl_b32 s64, s64, 1
    s_or_b32 s63, s63, s64
    v_and_b32 v249, 3, v2
    v_xor_b32 v249, s63, v249
    v_lshlrev_b32 v249, 5, v249
    v_and_b32_e64 v219, 2, v3
    v_lshl_add_u32 v249, v219, 3, v249
    v_and_b32_e64 v219, 1, v3
    v_lshl_add_u32 v249, v219, 18, v249
    v_lshrrev_b32_e64 v219, 2, v2
    v_lshl_add_u32 v249, v219, 16, v249
    s_lshl_b32 s62, s62, 7
    s_lshl_b32 s63, s61, 20
    s_add_u32 s62, s62, s63
    s_add_u32 s8, s62, 5242880
    s_add_u32 s9, s8, 0x40000
    s_add_u32 s10, s8, 0x80000
    s_add_u32 s11, s8, 0xc0000
    s_add_u32 s12, s62, 7340032
    s_add_u32 s13, s12, 0x40000
    s_add_u32 s14, s12, 0x80000
    s_add_u32 s15, s12, 0xc0000
    v_and_b32 v254, 127, v0
    v_lshlrev_b32_e64 v254, 4, v254
    s_lshl_b32 s62, s60, 11
    s_sub_u32 s16, 221184, s62
    s_add_u32 s17, s16, 12288
    s_add_u32 s18, s16, 24576
    s_add_u32 s19, s16, 36864
    v_mul_u32_u24 v218, 12288, v3
    v_lshl_add_u32 v218, v2, 4, v218
    s_lshl_b32 s62, s52, 8
    s_add_u32 s46, s62, 223232
    s_and_b32 s55, s52, 1
    s_lshl_b32 s83, s50, 1
    s_add_u32 s83, s83, s55
    s_cmp_eq_u32 s50, 3
    s_cselect_b32 s55, 1, 0
    s_sub_u32 s83, s83, s55
    s_add_u32 s84, s83, 1
    s_cmp_eq_u32 s84, 7
    s_cselect_b32 s84, 0, s84
    s_lshl_b32 s82, s50, 1
    s_xor_b32 s55, s82, 2
    s_cmp_ge_u32 s50, 2
    s_cselect_b32 s82, s55, s82
    s_mul_i32 s55, s52, 7
    s_add_u32 s96, s55, s83
    s_add_u32 s97, s55, s84
    s_add_u32 s100, s55, s82
    s_lshl_b32 s96, s96, 14
    s_lshl_b32 s97, s97, 14
    s_lshl_b32 s100, s100, 14
    s_add_u32 s96, s96, 3145728
    s_add_u32 s97, s97, 3145728
    s_add_u32 s100, s100, 4063232
    s_add_u32 s101, s100, 16384
    s_cmp_eq_u32 s50, 3
    s_cselect_b32 s96, 33554432, s96
    s_cmp_eq_u32 s50, 2
    s_cselect_b32 s101, 33554432, s101
    buffer_load_dwordx4 v[224:227], v254, s[4:7], s16 offen sc1
    buffer_load_dwordx4 v[228:231], v254, s[4:7], s17 offen sc1
    buffer_load_dwordx4 v[232:235], v254, s[4:7], s18 offen sc1
    buffer_load_dwordx4 v[236:239], v254, s[4:7], s19 offen sc1
    buffer_load_dwordx4 v[92:95], v218, s[4:7], s46 offen sc1
    s_waitcnt vmcnt(11)
    v_add_f32_dpp v62, v62, v62 quad_perm:[1,0,3,2] row_mask:0xf bank_mask:0xf
    s_nop 1
    v_add_f32_dpp v62, v62, v62 quad_perm:[2,3,0,1] row_mask:0xf bank_mask:0xf
    v_cvt_pk_bf16_f32 v62, v62, v62
    v_lshlrev_b32 v62, 16, v62
    v_add_f32_e64 v63, 1.0, v62
    v_cvt_pk_bf16_f32 v63, v63, v63
    v_lshlrev_b32_e64 v63, 16, v63
    v_readlane_b32 s74, v62, 0
    v_readlane_b32 s75, v62, 4
    v_readlane_b32 s72, v63, 8
    v_readlane_b32 s73, v63, 12
    v_mov_b32 v88, s74
    v_mov_b32 v89, s75
    s_waitcnt vmcnt(9)
    ds_write_b128 v246, v[64:67]
    ds_write_b128 v246, v[68:71] offset:4096
    v_lshlrev_b32 v16, 16, v64
    v_and_b32 v17, 0xffff0000, v64
    v_lshlrev_b32_e64 v18, 16, v65
    v_and_b32 v19, 0xffff0000, v65
    v_lshlrev_b32_e64 v20, 16, v66
    v_and_b32 v21, 0xffff0000, v66
    v_lshlrev_b32_e64 v22, 16, v67
    v_and_b32 v23, 0xffff0000, v67
    v_lshlrev_b32_e64 v24, 16, v68
    v_and_b32 v25, 0xffff0000, v68
    v_lshlrev_b32_e64 v26, 16, v69
    v_and_b32 v27, 0xffff0000, v69
    v_lshlrev_b32_e64 v28, 16, v70
    v_and_b32 v29, 0xffff0000, v70
    v_lshlrev_b32_e64 v30, 16, v71
    v_and_b32 v31, 0xffff0000, v71
    s_lshl_b32 s47, s2, 2
    s_add_u32 s47, s47, s50
    s_lshl_b32 s47, s47, 12
    s_add_u32 s47, s47, 13631488
    v_mov_b32 v56, -1
    v_mov_b32 v57, -1
    v_mov_b32 v58, -1
    v_mov_b32 v59, -1
    s_waitcnt vmcnt(7)
    v_pk_fma_f32 v[16:17], v[16:17], v[72:73], v[80:81]
    v_pk_fma_f32 v[18:19], v[18:19], v[74:75], v[82:83]
    v_pk_fma_f32 v[24:25], v[24:25], v[72:73], v[80:81]
    v_pk_fma_f32 v[26:27], v[26:27], v[74:75], v[82:83]
    v_pk_fma_f32 v[16:17], v[16:17], s[72:73], v[88:89] op_sel:[0,0,0] op_sel_hi:[1,0,0]
    v_pk_fma_f32 v[18:19], v[18:19], s[72:73], v[88:89] op_sel:[0,0,0] op_sel_hi:[1,0,0]
    v_pk_fma_f32 v[24:25], v[24:25], s[72:73], v[88:89] op_sel:[0,1,1] op_sel_hi:[1,1,1]
    v_pk_fma_f32 v[26:27], v[26:27], s[72:73], v[88:89] op_sel:[0,1,1] op_sel_hi:[1,1,1]
    v_cvt_pk_bf16_f32 v32, v16, v17
    v_cvt_pk_bf16_f32 v33, v18, v19
    v_cvt_pk_bf16_f32 v36, v24, v25
    v_cvt_pk_bf16_f32 v37, v26, v27
    s_waitcnt vmcnt(5)
    s_nop 0
    v_pk_fma_f32 v[20:21], v[20:21], v[76:77], v[84:85]
    v_pk_fma_f32 v[22:23], v[22:23], v[78:79], v[86:87]
    v_pk_fma_f32 v[28:29], v[28:29], v[76:77], v[84:85]
    v_pk_fma_f32 v[30:31], v[30:31], v[78:79], v[86:87]
    v_pk_fma_f32 v[20:21], v[20:21], s[72:73], v[88:89] op_sel:[0,0,0] op_sel_hi:[1,0,0]
    v_pk_fma_f32 v[22:23], v[22:23], s[72:73], v[88:89] op_sel:[0,0,0] op_sel_hi:[1,0,0]
    v_pk_fma_f32 v[28:29], v[28:29], s[72:73], v[88:89] op_sel:[0,1,1] op_sel_hi:[1,1,1]
    v_pk_fma_f32 v[30:31], v[30:31], s[72:73], v[88:89] op_sel:[0,1,1] op_sel_hi:[1,1,1]
    v_cvt_pk_bf16_f32 v34, v20, v21
    v_cvt_pk_bf16_f32 v35, v22, v23
    ds_write_b128 v245, v[32:35] offset:0
    v_cvt_pk_bf16_f32 v38, v28, v29
    v_cvt_pk_bf16_f32 v39, v30, v31
    ds_write_b128 v245, v[36:39] offset:4608
    s_waitcnt lgkmcnt(0)
    s_barrier
    ds_read_b128 v[160:163], v242 offset:192
    ds_read_b128 v[164:167], v242 offset:704
    ds_read_b128 v[168:171], v242 offset:1216
    ds_read_b128 v[172:175], v242 offset:1728
    ds_read_b128 v[176:179], v242 offset:2240
    ds_read_b128 v[180:183], v242 offset:2752
    ds_read_b128 v[184:187], v242 offset:3264
    ds_read_b128 v[188:191], v242 offset:3776
    v_readlane_b32 s78, v62, 16
    v_readlane_b32 s79, v62, 20
    v_readlane_b32 s80, v63, 24
    v_readlane_b32 s81, v63, 28
    s_lshl_b32 s76, s71, 16
    s_and_b32 s77, s71, 0xffff0000
    s_cmp_eq_u32 s60, 0
    s_cselect_b32 s76, s76, s77
    s_cselect_b32 s78, s78, s79
    s_cselect_b32 s80, s80, s81
    v_mov_b32 v90, s76
    v_mul_f32 v90, s78, v90
    buffer_store_dwordx4 v[56:59], v251, s[4:7], s47 offen offset:0 sc1
    s_waitcnt lgkmcnt(7)
    v_mfma_f32_16x16x32_bf16 v[96:99], v[128:131], v[160:163], 0
    s_waitcnt lgkmcnt(6)
    v_mfma_f32_16x16x32_bf16 v[100:103], v[128:131], v[164:167], 0
    v_mfma_f32_16x16x32_bf16 v[100:103], v[132:135], v[160:163], v[100:103]
    s_waitcnt lgkmcnt(5)
    v_mfma_f32_16x16x32_bf16 v[104:107], v[128:131], v[168:171], 0
    buffer_store_dwordx4 v[56:59], v251, s[4:7], s47 offen offset:1024 sc1
    v_mfma_f32_16x16x32_bf16 v[104:107], v[132:135], v[164:167], v[104:107]
    v_mfma_f32_16x16x32_bf16 v[104:107], v[136:139], v[160:163], v[104:107]
    s_waitcnt lgkmcnt(4)
    v_mfma_f32_16x16x32_bf16 v[108:111], v[128:131], v[172:175], 0
    ds_read_b128 v[192:195], v242 offset:128
    v_mfma_f32_16x16x32_bf16 v[108:111], v[132:135], v[168:171], v[108:111]
    ds_read_b64 v[16:17], v241 offset:3712
    buffer_store_dwordx4 v[56:59], v251, s[4:7], s47 offen offset:2048 sc1
    v_mfma_f32_16x16x32_bf16 v[108:111], v[136:139], v[164:167], v[108:111]
    ds_read_b64 v[18:19], v241 offset:3720
    v_mfma_f32_16x16x32_bf16 v[108:111], v[140:143], v[160:163], v[108:111]
    ds_read_b128 v[196:199], v242 offset:640
    s_waitcnt lgkmcnt(7)
    v_mfma_f32_16x16x32_bf16 v[112:115], v[128:131], v[176:179], 0
    ds_read_b64 v[20:21], v241 offset:3200
    v_mfma_f32_16x16x32_bf16 v[112:115], v[132:135], v[172:175], v[112:115]
    ds_read_b64 v[22:23], v241 offset:3208
    buffer_store_dwordx4 v[56:59], v251, s[4:7], s47 offen offset:3072 sc1
    v_mfma_f32_16x16x32_bf16 v[112:115], v[136:139], v[168:171], v[112:115]
    ds_read_b128 v[200:203], v242 offset:1152
    v_mfma_f32_16x16x32_bf16 v[112:115], v[140:143], v[164:167], v[112:115]
    ds_read_b64 v[24:25], v241 offset:2688
    v_mfma_f32_16x16x32_bf16 v[112:115], v[144:147], v[160:163], v[112:115]
    ds_read_b64 v[26:27], v241 offset:2696
    s_waitcnt lgkmcnt(11)
    v_mfma_f32_16x16x32_bf16 v[116:119], v[128:131], v[180:183], 0
    ds_read_b128 v[204:207], v242 offset:1664
    s_add_u32 s85, s96, 0
    v_mfma_f32_16x16x32_bf16 v[116:119], v[132:135], v[176:179], v[116:119]
    ds_read_b64 v[28:29], v241 offset:2176
    buffer_load_dwordx4 a[128:131], v251, s[4:7], s85 offen offset:0 sc1
    v_mfma_f32_16x16x32_bf16 v[116:119], v[136:139], v[172:175], v[116:119]
    ds_read_b64 v[30:31], v241 offset:2184
    v_mfma_f32_16x16x32_bf16 v[116:119], v[140:143], v[168:171], v[116:119]
    ds_read_b128 v[208:211], v242 offset:2176
    v_mfma_f32_16x16x32_bf16 v[116:119], v[144:147], v[164:167], v[116:119]
    ds_read_b64 v[32:33], v241 offset:1664
    v_mfma_f32_16x16x32_bf16 v[116:119], v[148:151], v[160:163], v[116:119]
    ds_read_b64 v[34:35], v241 offset:1672
    s_waitcnt lgkmcnt(15)
    v_mfma_f32_16x16x32_bf16 v[120:123], v[128:131], v[184:187], 0
    ds_read_b128 v[212:215], v242 offset:2688
    buffer_load_dwordx4 a[132:135], v251, s[4:7], s85 offen offset:1024 sc1
    v_mfma_f32_16x16x32_bf16 v[120:123], v[132:135], v[180:183], v[120:123]
    ds_read_b64 v[36:37], v241 offset:1152
    v_mfma_f32_16x16x32_bf16 v[120:123], v[136:139], v[176:179], v[120:123]
    ds_read_b64 v[38:39], v241 offset:1160
    v_mfma_f32_16x16x32_bf16 v[120:123], v[140:143], v[172:175], v[120:123]
    ds_read_b128 v[216:219], v242 offset:3200
    v_mfma_f32_16x16x32_bf16 v[120:123], v[144:147], v[168:171], v[120:123]
    ds_read_b64 v[40:41], v241 offset:640
    buffer_load_dwordx4 a[136:139], v251, s[4:7], s85 offen offset:2048 sc1
    v_mfma_f32_16x16x32_bf16 v[120:123], v[148:151], v[164:167], v[120:123]
    ds_read_b64 v[42:43], v241 offset:648
    v_mfma_f32_16x16x32_bf16 v[120:123], v[152:155], v[160:163], v[120:123]
    ds_read_b128 v[220:223], v242 offset:3712
    s_waitcnt lgkmcnt(15)
    v_mfma_f32_16x16x32_bf16 v[124:127], v[128:131], v[188:191], 0
    ds_read_b64 v[44:45], v241 offset:128
    v_mfma_f32_16x16x32_bf16 v[124:127], v[132:135], v[184:187], v[124:127]
    ds_read_b64 v[46:47], v241 offset:136
    buffer_load_dwordx4 a[140:143], v251, s[4:7], s85 offen offset:3072 sc1
    v_mfma_f32_16x16x32_bf16 v[124:127], v[136:139], v[180:183], v[124:127]
    v_mfma_f32_16x16x32_bf16 v[124:127], v[140:143], v[176:179], v[124:127]
    v_mfma_f32_16x16x32_bf16 v[124:127], v[144:147], v[172:175], v[124:127]
    s_add_u32 s85, s96, 4096
    v_mfma_f32_16x16x32_bf16 v[124:127], v[148:151], v[168:171], v[124:127]
    buffer_load_dwordx4 a[144:147], v251, s[4:7], s85 offen offset:0 sc1
    v_mfma_f32_16x16x32_bf16 v[124:127], v[152:155], v[164:167], v[124:127]
    v_mfma_f32_16x16x32_bf16 v[124:127], v[156:159], v[160:163], v[124:127]
    s_waitcnt lgkmcnt(0)
    v_mfma_f32_16x16x32_bf16 v[96:99], v[16:19], v[192:195], v[96:99]
    ds_read_b128 v[160:163], v242 offset:64
    v_mfma_f32_16x16x32_bf16 v[100:103], v[16:19], v[196:199], v[100:103]
    ds_read_b64 v[128:129], v241 offset:3648
    v_mfma_f32_16x16x32_bf16 v[100:103], v[20:23], v[192:195], v[100:103]
    buffer_load_dwordx4 a[148:151], v251, s[4:7], s85 offen offset:1024 sc1
    v_mfma_f32_16x16x32_bf16 v[104:107], v[16:19], v[200:203], v[104:107]
    ds_read_b64 v[130:131], v241 offset:3656
    v_mfma_f32_16x16x32_bf16 v[104:107], v[20:23], v[196:199], v[104:107]
    ds_read_b128 v[164:167], v242 offset:576
    v_mfma_f32_16x16x32_bf16 v[104:107], v[24:27], v[192:195], v[104:107]
    v_mfma_f32_16x16x32_bf16 v[108:111], v[16:19], v[204:207], v[108:111]
    ds_read_b64 v[132:133], v241 offset:3136
    v_mfma_f32_16x16x32_bf16 v[108:111], v[20:23], v[200:203], v[108:111]
    ds_read_b64 v[134:135], v241 offset:3144
    v_mfma_f32_16x16x32_bf16 v[108:111], v[24:27], v[196:199], v[108:111]
    buffer_load_dwordx4 a[152:155], v251, s[4:7], s85 offen offset:2048 sc1
    v_mfma_f32_16x16x32_bf16 v[108:111], v[28:31], v[192:195], v[108:111]
    ds_read_b128 v[168:171], v242 offset:1088
    v_mfma_f32_16x16x32_bf16 v[112:115], v[16:19], v[208:211], v[112:115]
    ds_read_b64 v[136:137], v241 offset:2624
    v_mfma_f32_16x16x32_bf16 v[112:115], v[20:23], v[204:207], v[112:115]
    v_mfma_f32_16x16x32_bf16 v[112:115], v[24:27], v[200:203], v[112:115]
    ds_read_b64 v[138:139], v241 offset:2632
    v_mfma_f32_16x16x32_bf16 v[112:115], v[28:31], v[196:199], v[112:115]
    ds_read_b128 v[172:175], v242 offset:1600
    v_mfma_f32_16x16x32_bf16 v[112:115], v[32:35], v[192:195], v[112:115]
    buffer_load_dwordx4 a[156:159], v251, s[4:7], s85 offen offset:3072 sc1
    v_mfma_f32_16x16x32_bf16 v[116:119], v[16:19], v[212:215], v[116:119]
    ds_read_b64 v[140:141], v241 offset:2112
    v_mfma_f32_16x16x32_bf16 v[116:119], v[20:23], v[208:211], v[116:119]
    ds_read_b64 v[142:143], v241 offset:2120
    v_mfma_f32_16x16x32_bf16 v[116:119], v[24:27], v[204:207], v[116:119]
    s_add_u32 s85, s97, 0
    v_mfma_f32_16x16x32_bf16 v[116:119], v[28:31], v[200:203], v[116:119]
    ds_read_b128 v[176:179], v242 offset:2112
    v_mfma_f32_16x16x32_bf16 v[116:119], v[32:35], v[196:199], v[116:119]
    ds_read_b64 v[144:145], v241 offset:1600
    v_mfma_f32_16x16x32_bf16 v[116:119], v[36:39], v[192:195], v[116:119]
    buffer_load_dwordx4 a[192:195], v251, s[4:7], s85 offen offset:0 sc1
    v_mfma_f32_16x16x32_bf16 v[120:123], v[16:19], v[216:219], v[120:123]
    ds_read_b64 v[146:147], v241 offset:1608
    v_mfma_f32_16x16x32_bf16 v[120:123], v[20:23], v[212:215], v[120:123]
    ds_read_b128 v[180:183], v242 offset:2624
    v_mfma_f32_16x16x32_bf16 v[120:123], v[24:27], v[208:211], v[120:123]
    v_mfma_f32_16x16x32_bf16 v[120:123], v[28:31], v[204:207], v[120:123]
    ds_read_b64 v[148:149], v241 offset:1088
    v_mfma_f32_16x16x32_bf16 v[120:123], v[32:35], v[200:203], v[120:123]
    ds_read_b64 v[150:151], v241 offset:1096
    v_mfma_f32_16x16x32_bf16 v[120:123], v[36:39], v[196:199], v[120:123]
    buffer_load_dwordx4 a[196:199], v251, s[4:7], s85 offen offset:1024 sc1
    v_mfma_f32_16x16x32_bf16 v[120:123], v[40:43], v[192:195], v[120:123]
    ds_read_b128 v[184:187], v242 offset:3136
    v_mfma_f32_16x16x32_bf16 v[124:127], v[16:19], v[220:223], v[124:127]
    ds_read_b64 v[152:153], v241 offset:576
    v_mfma_f32_16x16x32_bf16 v[124:127], v[20:23], v[216:219], v[124:127]
    v_mfma_f32_16x16x32_bf16 v[124:127], v[24:27], v[212:215], v[124:127]
    ds_read_b64 v[154:155], v241 offset:584
    v_mfma_f32_16x16x32_bf16 v[124:127], v[28:31], v[208:211], v[124:127]
    ds_read_b128 v[188:191], v242 offset:3648
    v_mfma_f32_16x16x32_bf16 v[124:127], v[32:35], v[204:207], v[124:127]
    buffer_load_dwordx4 a[200:203], v251, s[4:7], s85 offen offset:2048 sc1
    v_mfma_f32_16x16x32_bf16 v[124:127], v[36:39], v[200:203], v[124:127]
    ds_read_b64 v[156:157], v241 offset:64
    v_mfma_f32_16x16x32_bf16 v[124:127], v[40:43], v[196:199], v[124:127]
    ds_read_b64 v[158:159], v241 offset:72
    v_mfma_f32_16x16x32_bf16 v[124:127], v[44:47], v[192:195], v[124:127]
    s_waitcnt lgkmcnt(0)
    v_mfma_f32_16x16x32_bf16 v[96:99], v[128:131], v[160:163], v[96:99]
    ds_read_b128 v[192:195], v242 offset:0
    v_mfma_f32_16x16x32_bf16 v[100:103], v[128:131], v[164:167], v[100:103]
    ds_read_b64 v[16:17], v241 offset:3584
    v_mfma_f32_16x16x32_bf16 v[100:103], v[132:135], v[160:163], v[100:103]
    buffer_load_dwordx4 a[204:207], v251, s[4:7], s85 offen offset:3072 sc1
    v_mfma_f32_16x16x32_bf16 v[104:107], v[128:131], v[168:171], v[104:107]
    ds_read_b64 v[18:19], v241 offset:3592
    v_mfma_f32_16x16x32_bf16 v[104:107], v[132:135], v[164:167], v[104:107]
    ds_read_b128 v[196:199], v242 offset:512
    v_mfma_f32_16x16x32_bf16 v[104:107], v[136:139], v[160:163], v[104:107]
    s_add_u32 s85, s97, 4096
    v_mfma_f32_16x16x32_bf16 v[108:111], v[128:131], v[172:175], v[108:111]
    ds_read_b64 v[20:21], v241 offset:3072
    v_mfma_f32_16x16x32_bf16 v[108:111], v[132:135], v[168:171], v[108:111]
    ds_read_b64 v[22:23], v241 offset:3080
    v_mfma_f32_16x16x32_bf16 v[108:111], v[136:139], v[164:167], v[108:111]
    buffer_load_dwordx4 a[208:211], v251, s[4:7], s85 offen offset:0 sc1
    v_mfma_f32_16x16x32_bf16 v[108:111], v[140:143], v[160:163], v[108:111]
    ds_read_b128 v[200:203], v242 offset:1024
    v_mfma_f32_16x16x32_bf16 v[112:115], v[128:131], v[176:179], v[112:115]
    ds_read_b64 v[24:25], v241 offset:2560
    v_mfma_f32_16x16x32_bf16 v[112:115], v[132:135], v[172:175], v[112:115]
    v_mfma_f32_16x16x32_bf16 v[112:115], v[136:139], v[168:171], v[112:115]
    ds_read_b64 v[26:27], v241 offset:2568
    v_mfma_f32_16x16x32_bf16 v[112:115], v[140:143], v[164:167], v[112:115]
    ds_read_b128 v[204:207], v242 offset:1536
    v_mfma_f32_16x16x32_bf16 v[112:115], v[144:147], v[160:163], v[112:115]
    buffer_load_dwordx4 a[212:215], v251, s[4:7], s85 offen offset:1024 sc1
    v_mfma_f32_16x16x32_bf16 v[116:119], v[128:131], v[180:183], v[116:119]
    ds_read_b64 v[28:29], v241 offset:2048
    v_mfma_f32_16x16x32_bf16 v[116:119], v[132:135], v[176:179], v[116:119]
    ds_read_b64 v[30:31], v241 offset:2056
    v_mfma_f32_16x16x32_bf16 v[116:119], v[136:139], v[172:175], v[116:119]
    v_mfma_f32_16x16x32_bf16 v[116:119], v[140:143], v[168:171], v[116:119]
    ds_read_b128 v[208:211], v242 offset:2048
    v_mfma_f32_16x16x32_bf16 v[116:119], v[144:147], v[164:167], v[116:119]
    ds_read_b64 v[32:33], v241 offset:1536
    v_mfma_f32_16x16x32_bf16 v[116:119], v[148:151], v[160:163], v[116:119]
    buffer_load_dwordx4 a[216:219], v251, s[4:7], s85 offen offset:2048 sc1
    v_mfma_f32_16x16x32_bf16 v[120:123], v[128:131], v[184:187], v[120:123]
    ds_read_b64 v[34:35], v241 offset:1544
    v_mfma_f32_16x16x32_bf16 v[120:123], v[132:135], v[180:183], v[120:123]
    ds_read_b128 v[212:215], v242 offset:2560
    v_mfma_f32_16x16x32_bf16 v[120:123], v[136:139], v[176:179], v[120:123]
    v_mfma_f32_16x16x32_bf16 v[120:123], v[140:143], v[172:175], v[120:123]
    ds_read_b64 v[36:37], v241 offset:1024
    v_mfma_f32_16x16x32_bf16 v[120:123], v[144:147], v[168:171], v[120:123]
    ds_read_b64 v[38:39], v241 offset:1032
    v_mfma_f32_16x16x32_bf16 v[120:123], v[148:151], v[164:167], v[120:123]
    buffer_load_dwordx4 a[220:223], v251, s[4:7], s85 offen offset:3072 sc1
    v_mfma_f32_16x16x32_bf16 v[120:123], v[152:155], v[160:163], v[120:123]
    ds_read_b128 v[216:219], v242 offset:3072
    v_mfma_f32_16x16x32_bf16 v[124:127], v[128:131], v[188:191], v[124:127]
    ds_read_b64 v[40:41], v241 offset:512
    v_mfma_f32_16x16x32_bf16 v[124:127], v[132:135], v[184:187], v[124:127]
    s_add_u32 s85, s100, 0
    v_mfma_f32_16x16x32_bf16 v[124:127], v[136:139], v[180:183], v[124:127]
    ds_read_b64 v[42:43], v241 offset:520
    v_mfma_f32_16x16x32_bf16 v[124:127], v[140:143], v[176:179], v[124:127]
    ds_read_b128 v[220:223], v242 offset:3584
    v_mfma_f32_16x16x32_bf16 v[124:127], v[144:147], v[172:175], v[124:127]
    buffer_load_dwordx4 a[0:3], v251, s[4:7], s85 offen offset:0 sc1
    v_mfma_f32_16x16x32_bf16 v[124:127], v[148:151], v[168:171], v[124:127]
    ds_read_b64 v[44:45], v241 offset:0
    v_mfma_f32_16x16x32_bf16 v[124:127], v[152:155], v[164:167], v[124:127]
    ds_read_b64 v[46:47], v241 offset:8
    v_mfma_f32_16x16x32_bf16 v[124:127], v[156:159], v[160:163], v[124:127]
    s_waitcnt lgkmcnt(0)
    v_mfma_f32_16x16x32_bf16 v[96:99], v[16:19], v[192:195], v[96:99]
    ds_read_b64 v[128:129], v243 offset:0
    buffer_load_dwordx4 a[4:7], v251, s[4:7], s85 offen offset:1024 sc1
    v_mfma_f32_16x16x32_bf16 v[100:103], v[16:19], v[196:199], v[100:103]
    ds_read_b64 v[136:137], v244 offset:0
    v_mfma_f32_16x16x32_bf16 v[100:103], v[20:23], v[192:195], v[100:103]
    ds_read_b64 v[130:131], v243 offset:512
    v_mfma_f32_16x16x32_bf16 v[104:107], v[16:19], v[200:203], v[104:107]
    ds_read_b64 v[138:139], v244 offset:512
    v_mfma_f32_16x16x32_bf16 v[104:107], v[20:23], v[196:199], v[104:107]
    ds_read_b64 v[132:133], v243 offset:1024
    buffer_load_dwordx4 a[8:11], v251, s[4:7], s85 offen offset:2048 sc1
    v_mfma_f32_16x16x32_bf16 v[104:107], v[24:27], v[192:195], v[104:107]
    ds_read_b64 v[140:141], v244 offset:1024
    v_mfma_f32_16x16x32_bf16 v[108:111], v[16:19], v[204:207], v[108:111]
    ds_read_b64 v[134:135], v243 offset:1536
    v_mfma_f32_16x16x32_bf16 v[108:111], v[20:23], v[200:203], v[108:111]
    ds_read_b64 v[142:143], v244 offset:1536
    v_mfma_f32_16x16x32_bf16 v[108:111], v[24:27], v[196:199], v[108:111]
    buffer_load_dwordx4 a[12:15], v251, s[4:7], s85 offen offset:3072 sc1
    v_mfma_f32_16x16x32_bf16 v[108:111], v[28:31], v[192:195], v[108:111]
    v_mfma_f32_16x16x32_bf16 v[112:115], v[16:19], v[208:211], v[112:115]
    v_mfma_f32_16x16x32_bf16 v[112:115], v[20:23], v[204:207], v[112:115]
    s_waitcnt lgkmcnt(0)
    v_lshlrev_b32_e64 v144, 16, v128
    v_mfma_f32_16x16x32_bf16 v[112:115], v[24:27], v[200:203], v[112:115]
    v_and_b32 v145, 0xffff0000, v128
    v_lshlrev_b32_e64 v160, 16, v136
    v_mfma_f32_16x16x32_bf16 v[112:115], v[28:31], v[196:199], v[112:115]
    v_and_b32 v161, 0xffff0000, v136
    v_fmac_f32 v160, v90, v144
    v_mfma_f32_16x16x32_bf16 v[112:115], v[32:35], v[192:195], v[112:115]
    v_fmac_f32 v161, v90, v145
    v_lshlrev_b32_e64 v146, 16, v129
    v_mfma_f32_16x16x32_bf16 v[116:119], v[16:19], v[212:215], v[116:119]
    v_and_b32 v147, 0xffff0000, v129
    v_lshlrev_b32_e64 v162, 16, v137
    v_mfma_f32_16x16x32_bf16 v[116:119], v[20:23], v[208:211], v[116:119]
    v_and_b32 v163, 0xffff0000, v137
    v_fmac_f32 v162, v90, v146
    v_mfma_f32_16x16x32_bf16 v[116:119], v[24:27], v[204:207], v[116:119]
    v_fmac_f32 v163, v90, v147
    v_lshlrev_b32_e64 v148, 16, v130
    v_mfma_f32_16x16x32_bf16 v[116:119], v[28:31], v[200:203], v[116:119]
    v_and_b32 v149, 0xffff0000, v130
    v_lshlrev_b32_e64 v164, 16, v138
    v_mfma_f32_16x16x32_bf16 v[116:119], v[32:35], v[196:199], v[116:119]
    v_and_b32 v165, 0xffff0000, v138
    v_fmac_f32 v164, v90, v148
    v_mfma_f32_16x16x32_bf16 v[116:119], v[36:39], v[192:195], v[116:119]
    v_fmac_f32 v165, v90, v149
    v_lshlrev_b32_e64 v150, 16, v131
    v_mfma_f32_16x16x32_bf16 v[120:123], v[16:19], v[216:219], v[120:123]
    v_and_b32 v151, 0xffff0000, v131
    v_lshlrev_b32_e64 v166, 16, v139
    v_mfma_f32_16x16x32_bf16 v[120:123], v[20:23], v[212:215], v[120:123]
    v_and_b32 v167, 0xffff0000, v139
    v_fmac_f32 v166, v90, v150
    v_mfma_f32_16x16x32_bf16 v[120:123], v[24:27], v[208:211], v[120:123]
    v_fmac_f32 v167, v90, v151
    v_lshlrev_b32_e64 v152, 16, v132
    v_mfma_f32_16x16x32_bf16 v[120:123], v[28:31], v[204:207], v[120:123]
    v_and_b32 v153, 0xffff0000, v132
    v_lshlrev_b32_e64 v168, 16, v140
    v_mfma_f32_16x16x32_bf16 v[120:123], v[32:35], v[200:203], v[120:123]
    v_and_b32 v169, 0xffff0000, v140
    v_fmac_f32 v168, v90, v152
    v_mfma_f32_16x16x32_bf16 v[120:123], v[36:39], v[196:199], v[120:123]
    v_fmac_f32 v169, v90, v153
    v_lshlrev_b32_e64 v154, 16, v133
    v_mfma_f32_16x16x32_bf16 v[120:123], v[40:43], v[192:195], v[120:123]
    v_and_b32 v155, 0xffff0000, v133
    v_lshlrev_b32_e64 v170, 16, v141
    v_mfma_f32_16x16x32_bf16 v[124:127], v[16:19], v[220:223], v[124:127]
    v_and_b32 v171, 0xffff0000, v141
    v_fmac_f32 v170, v90, v154
    v_mfma_f32_16x16x32_bf16 v[124:127], v[20:23], v[216:219], v[124:127]
    v_fmac_f32 v171, v90, v155
    v_lshlrev_b32_e64 v156, 16, v134
    v_mfma_f32_16x16x32_bf16 v[124:127], v[24:27], v[212:215], v[124:127]
    v_and_b32 v157, 0xffff0000, v134
    v_lshlrev_b32_e64 v172, 16, v142
    v_mfma_f32_16x16x32_bf16 v[124:127], v[28:31], v[208:211], v[124:127]
    v_and_b32 v173, 0xffff0000, v142
    v_fmac_f32 v172, v90, v156
    v_mfma_f32_16x16x32_bf16 v[124:127], v[32:35], v[204:207], v[124:127]
    v_fmac_f32 v173, v90, v157
    v_lshlrev_b32_e64 v158, 16, v135
    v_mfma_f32_16x16x32_bf16 v[124:127], v[36:39], v[200:203], v[124:127]
    v_and_b32 v159, 0xffff0000, v135
    v_lshlrev_b32_e64 v174, 16, v143
    v_mfma_f32_16x16x32_bf16 v[124:127], v[40:43], v[196:199], v[124:127]
    v_and_b32 v175, 0xffff0000, v143
    v_fmac_f32 v174, v90, v158
    v_mfma_f32_16x16x32_bf16 v[124:127], v[44:47], v[192:195], v[124:127]
    v_fmac_f32 v175, v90, v159
    s_add_u32 s85, s100, 4096
    s_cmp_eq_u32 s61, 1
    s_cbranch_scc1 L_17
    v_pk_fma_f32 v[160:161], v[96:97], s[78:79], v[160:161] op_sel_hi:[1,0,1]
    v_pk_fma_f32 v[162:163], v[98:99], s[78:79], v[162:163] op_sel_hi:[1,0,1]
    ds_write_b128 v247, v[112:115] offset:0
    v_pk_fma_f32 v[164:165], v[100:101], s[78:79], v[164:165] op_sel_hi:[1,0,1]
    v_pk_fma_f32 v[166:167], v[102:103], s[78:79], v[166:167] op_sel_hi:[1,0,1]
    ds_write_b128 v247, v[116:119] offset:1024
    v_pk_fma_f32 v[168:169], v[104:105], s[78:79], v[168:169] op_sel_hi:[1,0,1]
    v_pk_fma_f32 v[170:171], v[106:107], s[78:79], v[170:171] op_sel_hi:[1,0,1]
    ds_write_b128 v247, v[120:123] offset:2048
    v_pk_fma_f32 v[172:173], v[108:109], s[78:79], v[172:173] op_sel_hi:[1,0,1]
    v_pk_fma_f32 v[174:175], v[110:111], s[78:79], v[174:175] op_sel_hi:[1,0,1]
    ds_write_b128 v247, v[124:127] offset:3072
    s_branch L_18
L_17:
    ds_write_b128 v247, v[96:99] offset:0
    ds_write_b128 v247, v[100:103] offset:1024
    ds_write_b128 v247, v[104:107] offset:2048
    ds_write_b128 v247, v[108:111] offset:3072
    s_nop 0
    v_pk_fma_f32 v[160:161], v[112:113], s[78:79], v[160:161] op_sel_hi:[1,0,1]
    v_pk_fma_f32 v[162:163], v[114:115], s[78:79], v[162:163] op_sel_hi:[1,0,1]
    v_pk_fma_f32 v[164:165], v[116:117], s[78:79], v[164:165] op_sel_hi:[1,0,1]
    v_pk_fma_f32 v[166:167], v[118:119], s[78:79], v[166:167] op_sel_hi:[1,0,1]
    v_pk_fma_f32 v[168:169], v[120:121], s[78:79], v[168:169] op_sel_hi:[1,0,1]
    v_pk_fma_f32 v[170:171], v[122:123], s[78:79], v[170:171] op_sel_hi:[1,0,1]
    v_pk_fma_f32 v[172:173], v[124:125], s[78:79], v[172:173] op_sel_hi:[1,0,1]
    v_pk_fma_f32 v[174:175], v[126:127], s[78:79], v[174:175] op_sel_hi:[1,0,1]
L_18:
    s_waitcnt lgkmcnt(0)
    s_barrier
    ds_read_b128 v[176:179], v248 offset:0
    ds_read_b128 v[180:183], v248 offset:1024
    ds_read_b128 v[184:187], v248 offset:2048
    ds_read_b128 v[188:191], v248 offset:3072
    buffer_load_dwordx4 a[16:19], v251, s[4:7], s85 offen offset:0 sc1
    s_waitcnt lgkmcnt(3)
    s_nop 0
    v_pk_fma_f32 v[160:161], v[176:177], s[78:79], v[160:161] op_sel_hi:[1,0,1]
    v_pk_fma_f32 v[162:163], v[178:179], s[78:79], v[162:163] op_sel_hi:[1,0,1]
    v_pk_mul_f32 v[144:145], v[160:161], s[80:81] op_sel_hi:[1,0]
    v_pk_mul_f32 v[146:147], v[162:163], s[80:81] op_sel_hi:[1,0]
    v_cvt_pk_bf16_f32 v136, v160, v161
    v_cvt_pk_bf16_f32 v137, v162, v163
    v_cvt_pk_bf16_f32 v128, v144, v145
    v_cvt_pk_bf16_f32 v129, v146, v147
    s_waitcnt lgkmcnt(2)
    s_nop 0
    v_pk_fma_f32 v[164:165], v[180:181], s[78:79], v[164:165] op_sel_hi:[1,0,1]
    v_pk_fma_f32 v[166:167], v[182:183], s[78:79], v[166:167] op_sel_hi:[1,0,1]
    v_pk_mul_f32 v[148:149], v[164:165], s[80:81] op_sel_hi:[1,0]
    v_pk_mul_f32 v[150:151], v[166:167], s[80:81] op_sel_hi:[1,0]
    v_cvt_pk_bf16_f32 v138, v164, v165
    v_cvt_pk_bf16_f32 v139, v166, v167
    v_cvt_pk_bf16_f32 v130, v148, v149
    v_cvt_pk_bf16_f32 v131, v150, v151
    v_permlane16_swap_b32 v136, v138
    v_permlane16_swap_b32 v137, v139
    v_permlane16_swap_b32 v128, v130
    v_permlane16_swap_b32 v129, v131
    buffer_store_dwordx4 v[128:131], v249, s[4:7], s8 offen sc1
    buffer_store_dwordx4 v[136:139], v249, s[4:7], s12 offen sc1
    s_waitcnt lgkmcnt(1)
    s_nop 0
    v_pk_fma_f32 v[168:169], v[184:185], s[78:79], v[168:169] op_sel_hi:[1,0,1]
    v_pk_fma_f32 v[170:171], v[186:187], s[78:79], v[170:171] op_sel_hi:[1,0,1]
    v_pk_mul_f32 v[152:153], v[168:169], s[80:81] op_sel_hi:[1,0]
    v_pk_mul_f32 v[154:155], v[170:171], s[80:81] op_sel_hi:[1,0]
    v_cvt_pk_bf16_f32 v140, v168, v169
    v_cvt_pk_bf16_f32 v141, v170, v171
    v_cvt_pk_bf16_f32 v132, v152, v153
    v_cvt_pk_bf16_f32 v133, v154, v155
    s_waitcnt lgkmcnt(0)
    s_nop 0
    v_pk_fma_f32 v[172:173], v[188:189], s[78:79], v[172:173] op_sel_hi:[1,0,1]
    v_pk_fma_f32 v[174:175], v[190:191], s[78:79], v[174:175] op_sel_hi:[1,0,1]
    v_pk_mul_f32 v[156:157], v[172:173], s[80:81] op_sel_hi:[1,0]
    v_pk_mul_f32 v[158:159], v[174:175], s[80:81] op_sel_hi:[1,0]
    v_cvt_pk_bf16_f32 v142, v172, v173
    v_cvt_pk_bf16_f32 v143, v174, v175
    v_cvt_pk_bf16_f32 v134, v156, v157
    v_cvt_pk_bf16_f32 v135, v158, v159
    v_permlane16_swap_b32 v140, v142
    v_permlane16_swap_b32 v141, v143
    v_permlane16_swap_b32 v132, v134
    v_permlane16_swap_b32 v133, v135
    buffer_store_dwordx4 v[132:135], v249, s[4:7], s10 offen sc1
    buffer_store_dwordx4 v[140:143], v249, s[4:7], s14 offen sc1
    s_cmp_eq_u32 s60, 0
    s_cselect_b32 s56, 1.0, 0
    s_waitcnt vmcnt(29)
    v_lshlrev_b32 v6, 3, v0
    v_add_u32 v6, 155904, v6
    v_pk_add_f32 v[224:225], v[224:225], v[228:229]
    v_pk_add_f32 v[226:227], v[226:227], v[230:231]
    v_pk_add_f32 v[232:233], v[232:233], v[236:237]
    v_pk_add_f32 v[234:235], v[234:235], v[238:239]
    v_pk_add_f32 v[224:225], v[224:225], v[232:233]
    v_pk_add_f32 v[226:227], v[226:227], v[234:235]
    v_cvt_pk_bf16_f32 v228, v224, v225
    v_cvt_pk_bf16_f32 v229, v226, v227
    v_lshlrev_b32_e64 v224, 16, v228
    v_and_b32 v225, 0xffff0000, v228
    v_lshlrev_b32_e64 v226, 16, v229
    v_and_b32 v227, 0xffff0000, v229
    v_pk_add_f32 v[224:225], v[224:225], s[56:57] op_sel_hi:[1,0]
    v_pk_add_f32 v[226:227], v[226:227], s[56:57] op_sel_hi:[1,0]
    v_cvt_pk_bf16_f32 v228, v224, v225
    v_cvt_pk_bf16_f32 v229, v226, v227
    buffer_load_dwordx4 a[20:23], v251, s[4:7], s85 offen offset:1024 sc1
    ds_write_b64 v6, v[228:229]
    v_mov_b32 v224, v92
    v_mov_b32 v225, v93
    v_mov_b32 v226, v94
    v_mov_b32 v227, v95
    v_permlane32_swap_b32 v224, v92
    v_permlane32_swap_b32 v225, v93
    v_permlane32_swap_b32 v226, v94
    v_permlane32_swap_b32 v227, v95
    v_pk_add_f32 v[92:93], v[92:93], v[224:225]
    v_pk_add_f32 v[94:95], v[94:95], v[226:227]
    v_mov_b32 v224, v92
    v_mov_b32 v225, v93
    v_mov_b32 v226, v94
    v_mov_b32 v227, v95
    v_permlane16_swap_b32 v224, v92
    buffer_load_dwordx4 a[24:27], v251, s[4:7], s85 offen offset:2048 sc1
    v_permlane16_swap_b32 v225, v93
    v_permlane16_swap_b32 v226, v94
    v_permlane16_swap_b32 v227, v95
    v_pk_add_f32 v[92:93], v[92:93], v[224:225]
    v_pk_add_f32 v[94:95], v[94:95], v[226:227]
    v_lshlrev_b32_e64 v6, 3, v2
    v_add_u32 v6, 155648, v6
    v_cvt_pk_bf16_f32 v92, v92, v93
    v_cvt_pk_bf16_f32 v93, v94, v95
    ds_write_b64 v6, v[92:93]
    v_and_b32 v5, 1, v2
    v_lshlrev_b32 v5, 10, v5
    v_lshl_add_u32 v5, v3, 4, v5
    v_add_u32 v45, 155904, v5
    v_lshlrev_b32 v47, 4, v1
    v_lshrrev_b32 v4, 2, v2
    buffer_load_dwordx4 a[28:31], v251, s[4:7], s85 offen offset:3072 sc1
    v_and_b32 v8, 3, v2
    v_and_b32 v9, 2, v4
    v_and_b32 v10, 1, v3
    v_or_b32 v9, v9, v10
    v_lshl_add_u32 v5, v3, 3, v4
    v_lshlrev_b32_e64 v5, 7, v5
    v_lshl_add_u32 v5, v8, 3, v5
    v_xor_b32_e64 v10, 0, v9
    v_lshl_add_u32 v40, v10, 5, v5
    v_xor_b32_e64 v10, 1, v9
    v_lshl_add_u32 v41, v10, 5, v5
    v_xor_b32_e64 v10, 2, v9
    v_lshl_add_u32 v226, v10, 5, v5
    v_xor_b32_e64 v10, 3, v9
    v_lshl_add_u32 v227, v10, 5, v5
    v_xor_b32 v10, s50, v9
    s_add_u32 s85, s101, 0
    buffer_load_dwordx4 a[64:67], v251, s[4:7], s85 offen offset:0 sc1
    v_lshl_add_u32 v44, v10, 5, v5
    v_add_u32 v44, 0x10000, v44
    v_mov_b32 v46, 0xc0135761
    v_lshrrev_b32 v5, 5, v1
    v_and_b32 v207, 31, v1
    v_lshlrev_b32 v10, 3, v5
    v_xor_b32 v207, v207, v10
    v_lshlrev_b32_e64 v207, 4, v207
    v_lshl_add_u32 v207, v5, 12, v207
    v_lshrrev_b32_e64 v5, 1, v2
    v_mul_u32_u24 v208, 1040, v5
    v_lshl_add_u32 v208, v3, 3, v208
    v_mov_b32 v5, 8320
    v_mad_u32_u24 v208, s50, v5, v208
    v_mul_u32_u24 v10, s50, v5
    v_and_b32 v5, 1, v2
    buffer_load_dwordx4 a[68:71], v251, s[4:7], s85 offen offset:1024 sc1
    v_mul_u32_u24 v209, 384, v5
    v_mul_u32_u24 v5, 640, v5
    v_add_u32 v209, v209, v208
    v_add_u32 v208, v5, v208
    v_add_u32 v10, 73728, v10
    v_add_u32 v204, v10, v208
    v_add_u32 v205, v10, v209
    v_lshl_add_u32 v42, v3, 2, v4
    v_bfe_u32 v43, v42, 3, 1
    v_and_b32 v5, 2, v42
    v_or_b32 v43, v43, v5
    v_xor_b32 v43, s50, v43
    v_lshlrev_b32 v42, 7, v42
    v_lshl_add_u32 v42, v43, 5, v42
    v_lshl_add_u32 v42, v8, 3, v42
    v_add_u32 v42, 0x10000, v42
    buffer_load_dwordx4 a[72:75], v251, s[4:7], s85 offen offset:2048 sc1
    v_lshlrev_b32 v206, 3, v1
    v_lshlrev_b32_e64 v229, 7, v1
    buffer_load_dwordx4 a[76:79], v251, s[4:7], s85 offen offset:3072 sc1
    s_add_u32 s85, s101, 4096
    buffer_load_dwordx4 a[80:83], v251, s[4:7], s85 offen offset:0 sc1
    buffer_load_dwordx4 a[84:87], v251, s[4:7], s85 offen offset:1024 sc1
    buffer_load_dwordx4 a[88:91], v251, s[4:7], s85 offen offset:2048 sc1
    s_and_b32 s53, s2, 7
    s_add_u32 s53, s53, 64
    s_lshl_b32 s68, s53, 7
    v_mul_u32_u24 v6, 1024, v1
    v_mov_b32 v7, 1
    s_waitcnt vmcnt(10) lgkmcnt(0)
    s_barrier
    s_cmp_eq_u32 s50, 0
    s_cbranch_scc0 sig_19
    s_mov_b64 exec, 0xff
    buffer_atomic_add v7, v6, s[4:7], s68 offen sc1
    s_mov_b64 exec, -1
sig_19:
    buffer_load_dwordx4 a[92:95], v251, s[4:7], s85 offen offset:3072 sc1
    s_add_u32 s85, s96, 8192
    buffer_load_dwordx4 a[160:163], v251, s[4:7], s85 offen offset:0 sc1
    buffer_load_dwordx4 a[164:167], v251, s[4:7], s85 offen offset:1024 sc1
    buffer_load_dwordx4 a[168:171], v251, s[4:7], s85 offen offset:2048 sc1
    buffer_load_dwordx4 a[172:175], v251, s[4:7], s85 offen offset:3072 sc1
    s_add_u32 s85, s96, 12288
    buffer_load_dwordx4 a[176:179], v251, s[4:7], s85 offen offset:0 sc1
    buffer_load_dwordx4 a[180:183], v251, s[4:7], s85 offen offset:1024 sc1
    buffer_load_dwordx4 a[184:187], v251, s[4:7], s85 offen offset:2048 sc1
    ds_read_b128 v[48:51], v45 offset:0
    ds_read_b128 v[52:55], v45 offset:64
    ds_read_b128 v[56:59], v45 offset:128
    ds_read_b128 v[60:63], v45 offset:192
    ds_read_b128 v[64:67], v45 offset:256
    ds_read_b128 v[68:71], v45 offset:320
    ds_read_b128 v[72:75], v45 offset:384
    ds_read_b128 v[76:79], v45 offset:448
    ds_read_b128 v[80:83], v45 offset:512
    ds_read_b128 v[84:87], v45 offset:576
    buffer_load_dwordx4 a[188:191], v251, s[4:7], s85 offen offset:3072 sc1
    ds_read_b128 v[88:91], v45 offset:640
    ds_read_b128 v[92:95], v45 offset:704
    ds_read_b128 v[96:99], v45 offset:768
    ds_read_b128 v[100:103], v45 offset:832
    ds_read_b128 v[104:107], v45 offset:896
    ds_read_b128 v[108:111], v45 offset:960
    s_and_b32 s53, s2, 7
    s_lshl_b32 s53, s53, 10
    s_add_u32 s53, s53, 8192
    v_lshl_add_u32 v4, v1, 7, s53
    s_waitcnt vmcnt(8) lgkmcnt(0)
    v_mfma_f32_16x16x32_bf16 v[8:11], v[48:51], a[0:3], 0
    s_add_u32 s85, s97, 8192
    buffer_load_dwordx4 a[224:227], v251, s[4:7], s85 offen offset:0 sc1
    v_mfma_f32_16x16x32_bf16 v[16:19], a[128:131], v[48:51], 0
    s_mov_b32 s58, 0xbdd2d3e8
    s_lshl_b32 s53, s51, 16
    v_mfma_f32_16x16x32_bf16 v[12:15], v[48:51], a[64:67], 0
    s_lshl_b32 s56, s52, 13
    s_add_u32 s92, s53, s56
    v_mfma_f32_16x16x32_bf16 v[20:23], a[192:195], v[48:51], 0
    s_lshl_b32 s93, s50, 11
    s_add_u32 s92, s92, s93
    v_mfma_f32_16x16x32_bf16 v[8:11], v[52:55], a[4:7], v[8:11]
    buffer_load_dwordx4 a[228:231], v251, s[4:7], s85 offen offset:1024 sc1
    v_mfma_f32_16x16x32_bf16 v[16:19], a[132:135], v[52:55], v[16:19]
    s_add_u32 s92, s92, 7340032
    s_lshl_b32 s32, s51, 18
    v_mfma_f32_16x16x32_bf16 v[12:15], v[52:55], a[68:71], v[12:15]
    s_lshl_b32 s53, s50, 10
    s_add_u32 s32, s32, s53
    v_mfma_f32_16x16x32_bf16 v[20:23], a[196:199], v[52:55], v[20:23]
    s_mul_i32 s90, s50, 16640
    s_mul_i32 s59, s50, 8320
    v_mfma_f32_16x16x32_bf16 v[8:11], v[56:59], a[8:11], v[8:11]
    buffer_load_dwordx4 a[232:235], v251, s[4:7], s85 offen offset:2048 sc1
    v_mfma_f32_16x16x32_bf16 v[16:19], a[136:139], v[56:59], v[16:19]
    s_lshl_b32 s60, s51, 12
    s_add_u32 s94, s60, 524288
    v_mfma_f32_16x16x32_bf16 v[12:15], v[56:59], a[72:75], v[12:15]
    s_add_u32 s60, s60, 262144
    s_lshl_b32 s95, s50, 9
    v_mfma_f32_16x16x32_bf16 v[20:23], a[200:203], v[56:59], v[20:23]
    s_add_u32 s95, s95, 160512
    s_lshl_b32 s56, s52, 9
    v_mfma_f32_16x16x32_bf16 v[8:11], v[60:63], a[12:15], v[8:11]
    buffer_load_dwordx4 a[236:239], v251, s[4:7], s85 offen offset:3072 sc1
    v_mfma_f32_16x16x32_bf16 v[16:19], a[140:143], v[60:63], v[16:19]
    s_add_u32 s61, s56, s60
    s_add_u32 s62, s56, s94
    v_mfma_f32_16x16x32_bf16 v[12:15], v[60:63], a[76:79], v[12:15]
    s_lshr_b32 s56, s93, 4
    s_add_u32 s62, s62, s56
    v_mfma_f32_16x16x32_bf16 v[20:23], a[204:207], v[60:63], v[20:23]
    s_add_u32 s70, s61, 131072
    s_add_u32 s71, s62, 131072
    v_mfma_f32_16x16x32_bf16 v[8:11], v[64:67], a[16:19], v[8:11]
    s_add_u32 s85, s97, 12288
    buffer_load_dwordx4 a[240:243], v251, s[4:7], s85 offen offset:0 sc1
    v_mfma_f32_16x16x32_bf16 v[16:19], a[144:147], v[64:67], v[16:19]
    s_lshr_b32 s56, s52, 2
    s_mul_i32 s56, s56, 0
    v_mfma_f32_16x16x32_bf16 v[12:15], v[64:67], a[80:83], v[12:15]
    s_add_u32 s60, s60, s56
    s_add_u32 s94, s94, s56
    v_mfma_f32_16x16x32_bf16 v[20:23], a[208:211], v[64:67], v[20:23]
    s_mul_i32 s63, s52, 7
    s_add_u32 s63, s63, s82
    v_mfma_f32_16x16x32_bf16 v[8:11], v[68:71], a[20:23], v[8:11]
    buffer_load_dwordx4 a[244:247], v251, s[4:7], s85 offen offset:1024 sc1
    v_mfma_f32_16x16x32_bf16 v[16:19], a[148:151], v[68:71], v[16:19]
    s_lshl_b32 s63, s63, 5
    s_add_u32 s63, s63, s51
    v_mfma_f32_16x16x32_bf16 v[12:15], v[68:71], a[84:87], v[12:15]
    s_lshl_b32 s63, s63, 11
    s_add_u32 s63, s63, 9437184
    v_mfma_f32_16x16x32_bf16 v[20:23], a[212:215], v[68:71], v[20:23]
    s_add_u32 s64, s63, 65536
    s_lshl_b32 s79, s52, 2
    v_mfma_f32_16x16x32_bf16 v[8:11], v[72:75], a[24:27], v[8:11]
    buffer_load_dwordx4 a[248:251], v251, s[4:7], s85 offen offset:2048 sc1
    v_mfma_f32_16x16x32_bf16 v[16:19], a[152:155], v[72:75], v[16:19]
    s_add_u32 s79, s79, s50
    s_mul_i32 s80, s51, 28
    v_mfma_f32_16x16x32_bf16 v[12:15], v[72:75], a[88:91], v[12:15]
    s_add_u32 s80, s80, s79
    s_lshl_b32 s80, s80, 12
    v_mfma_f32_16x16x32_bf16 v[20:23], a[216:219], v[72:75], v[20:23]
    s_add_u32 s80, s80, 13631488
    s_lshl_b32 s81, s51, 2
    v_mfma_f32_16x16x32_bf16 v[8:11], v[76:79], a[28:31], v[8:11]
    buffer_load_dwordx4 a[252:255], v251, s[4:7], s85 offen offset:3072 sc1
    v_mfma_f32_16x16x32_bf16 v[16:19], a[156:159], v[76:79], v[16:19]
    s_add_u32 s81, s81, s79
    s_lshl_b32 s81, s81, 12
    v_mfma_f32_16x16x32_bf16 v[12:15], v[76:79], a[92:95], v[12:15]
    s_add_u32 s81, s81, 17186816
    s_cmp_ge_u32 s79, 28
    s_cselect_b32 s80, s81, s80
    v_mfma_f32_16x16x32_bf16 v[20:23], a[220:223], v[76:79], v[20:23]
    v_mov_b32 v232, -1
    v_mov_b32 v233, -1
    v_mov_b32 v234, -1
    s_add_u32 s85, s100, 8192
    buffer_load_dwordx4 a[32:35], v251, s[4:7], s85 offen offset:0 sc1
    v_mov_b32 v235, -1
    s_cmp_eq_u32 s50, 2
    s_cselect_b32 s64, 33554432, s64
    s_add_u32 s33, s32, 8192
    s_add_u32 s34, s32, 16384
    s_add_u32 s35, s32, 24576
    s_add_u32 s36, s32, 32768
    s_add_u32 s37, s32, 40960
    buffer_load_dwordx4 a[36:39], v251, s[4:7], s85 offen offset:1024 sc1
    s_add_u32 s38, s32, 49152
    s_add_u32 s39, s32, 57344
    v_mov_b32 v152, 0x3f803f80
    v_mov_b32 v153, 0x3f803f80
    v_mov_b32 v154, 0x3f803f80
    v_mov_b32 v155, 0x3f803f80
    v_and_b32_e64 v6, 3, v2
    v_cmp_eq_u32 s[66:67], 1, v6
    buffer_load_dwordx4 a[40:43], v251, s[4:7], s85 offen offset:2048 sc1
    v_cmp_eq_u32 s[72:73], 2, v6
    v_cmp_eq_u32 s[74:75], 3, v6
    v_lshrrev_b32_e64 v7, 2, v2
    v_cmp_eq_u32 s[76:77], v7, v3
    v_lshlrev_b32 v230, 3, v2
    s_lshl_b32 s86, s50, 10
    s_lshl_b32 s87, s51, 16
    s_add_u32 s87, s87, 5242880
    buffer_load_dwordx4 a[44:47], v251, s[4:7], s85 offen offset:3072 sc1
    v_add_u32 v231, s87, v47
    s_add_u32 s85, s100, 12288
    buffer_load_dwordx4 a[48:51], v251, s[4:7], s85 offen offset:0 sc1
    buffer_load_dwordx4 a[52:55], v251, s[4:7], s85 offen offset:1024 sc1
    buffer_load_dwordx4 a[56:59], v251, s[4:7], s85 offen offset:2048 sc1
    buffer_load_dwordx4 a[60:63], v251, s[4:7], s85 offen offset:3072 sc1
    s_add_u32 s85, s101, 8192
    buffer_load_dwordx4 a[96:99], v251, s[4:7], s85 offen offset:0 sc1
    buffer_load_dwordx4 a[100:103], v251, s[4:7], s85 offen offset:1024 sc1
    buffer_load_dwordx4 a[104:107], v251, s[4:7], s85 offen offset:2048 sc1
    buffer_load_dwordx4 a[108:111], v251, s[4:7], s85 offen offset:3072 sc1
    s_mov_b64 exec, 0xff
    buffer_load_dword v5, v4, s[4:7], 0 offen sc1
    s_mov_b64 exec, -1
    s_add_u32 s85, s101, 12288
    buffer_load_dwordx4 a[112:115], v251, s[4:7], s85 offen offset:0 sc1
    buffer_load_dwordx4 a[116:119], v251, s[4:7], s85 offen offset:1024 sc1
    buffer_load_dwordx4 a[120:123], v251, s[4:7], s85 offen offset:2048 sc1
    buffer_load_dwordx4 a[124:127], v251, s[4:7], s85 offen offset:3072 sc1
    s_cmp_eq_u32 s50, 0
    s_cbranch_scc0 L_20
    s_mov_b64 exec, 0xff
    s_mov_b32 s54, 0
    s_waitcnt vmcnt(4)
    s_branch poll_21c
poll_21:
    buffer_load_dword v5, v4, s[4:7], 0 offen sc1
    s_waitcnt vmcnt(0)
poll_21c:
    v_cmp_gt_u32 vcc, 32, v5
    s_add_u32 s54, s54, 1
    s_cbranch_vccz pollx_22
    s_sleep 4
    s_cmp_lt_u32 s54, 0x40000
    s_cbranch_scc1 poll_21
pollx_22:
    s_mov_b64 exec, -1
L_20:
    s_barrier
    s_add_u32 m0, s93, 0x10000
    s_nop 0
    buffer_load_dwordx4 v47, s[4:7], s92 offen sc1 lds
    buffer_load_dwordx4 v47, s[4:7], s92 offen offset:1024 sc1 lds
    s_add_u32 m0, s86, 0
    s_nop 0
    buffer_load_dwordx4 v231, s[4:7], m0 offen sc1 lds
    s_add_u32 m0, m0, 4096
    s_nop 0
    buffer_load_dwordx4 v231, s[4:7], m0 offen sc1 lds
    s_add_u32 m0, m0, 4096
    s_nop 0
    buffer_load_dwordx4 v231, s[4:7], m0 offen sc1 lds
    s_add_u32 m0, m0, 4096
    s_nop 0
    buffer_load_dwordx4 v231, s[4:7], m0 offen sc1 lds
    s_add_u32 m0, m0, 4096
    s_nop 0
    buffer_load_dwordx4 v231, s[4:7], m0 offen sc1 lds
    s_add_u32 m0, m0, 4096
    s_nop 0
    buffer_load_dwordx4 v231, s[4:7], m0 offen sc1 lds
    s_add_u32 m0, m0, 4096
    s_nop 0
    buffer_load_dwordx4 v231, s[4:7], m0 offen sc1 lds
    s_add_u32 m0, m0, 4096
    s_nop 0
    buffer_load_dwordx4 v231, s[4:7], m0 offen sc1 lds
    s_add_u32 m0, m0, 4096
    s_nop 0
    buffer_load_dwordx4 v231, s[4:7], m0 offen sc1 lds
    s_add_u32 m0, m0, 4096
    s_nop 0
    buffer_load_dwordx4 v231, s[4:7], m0 offen sc1 lds
    s_add_u32 m0, m0, 4096
    s_waitcnt vmcnt(12)
    v_mfma_f32_16x16x32_bf16 v[8:11], v[80:83], a[32:35], v[8:11]
    v_mfma_f32_16x16x32_bf16 v[16:19], a[160:163], v[80:83], v[16:19]
    v_mfma_f32_16x16x32_bf16 v[12:15], v[80:83], a[96:99], v[12:15]
    v_mfma_f32_16x16x32_bf16 v[20:23], a[224:227], v[80:83], v[20:23]
    v_mfma_f32_16x16x32_bf16 v[8:11], v[84:87], a[36:39], v[8:11]
    v_mfma_f32_16x16x32_bf16 v[16:19], a[164:167], v[84:87], v[16:19]
    v_mfma_f32_16x16x32_bf16 v[12:15], v[84:87], a[100:103], v[12:15]
    v_mfma_f32_16x16x32_bf16 v[20:23], a[228:231], v[84:87], v[20:23]
    v_mfma_f32_16x16x32_bf16 v[8:11], v[88:91], a[40:43], v[8:11]
    v_mfma_f32_16x16x32_bf16 v[16:19], a[168:171], v[88:91], v[16:19]
    v_mfma_f32_16x16x32_bf16 v[12:15], v[88:91], a[104:107], v[12:15]
    v_mfma_f32_16x16x32_bf16 v[20:23], a[232:235], v[88:91], v[20:23]
    v_mfma_f32_16x16x32_bf16 v[8:11], v[92:95], a[44:47], v[8:11]
    v_mfma_f32_16x16x32_bf16 v[16:19], a[172:175], v[92:95], v[16:19]
    v_mfma_f32_16x16x32_bf16 v[12:15], v[92:95], a[108:111], v[12:15]
    v_mfma_f32_16x16x32_bf16 v[20:23], a[236:239], v[92:95], v[20:23]
    v_mfma_f32_16x16x32_bf16 v[8:11], v[96:99], a[48:51], v[8:11]
    v_mfma_f32_16x16x32_bf16 v[16:19], a[176:179], v[96:99], v[16:19]
    v_mfma_f32_16x16x32_bf16 v[12:15], v[96:99], a[112:115], v[12:15]
    v_mfma_f32_16x16x32_bf16 v[20:23], a[240:243], v[96:99], v[20:23]
    v_mfma_f32_16x16x32_bf16 v[8:11], v[100:103], a[52:55], v[8:11]
    v_mfma_f32_16x16x32_bf16 v[16:19], a[180:183], v[100:103], v[16:19]
    v_mfma_f32_16x16x32_bf16 v[12:15], v[100:103], a[116:119], v[12:15]
    v_mfma_f32_16x16x32_bf16 v[20:23], a[244:247], v[100:103], v[20:23]
    v_mfma_f32_16x16x32_bf16 v[8:11], v[104:107], a[56:59], v[8:11]
    v_mfma_f32_16x16x32_bf16 v[16:19], a[184:187], v[104:107], v[16:19]
    v_mfma_f32_16x16x32_bf16 v[12:15], v[104:107], a[120:123], v[12:15]
    v_mfma_f32_16x16x32_bf16 v[20:23], a[248:251], v[104:107], v[20:23]
    v_mfma_f32_16x16x32_bf16 v[8:11], v[108:111], a[60:63], v[8:11]
    v_mfma_f32_16x16x32_bf16 v[16:19], a[188:191], v[108:111], v[16:19]
    v_mfma_f32_16x16x32_bf16 v[12:15], v[108:111], a[124:127], v[12:15]
    v_mfma_f32_16x16x32_bf16 v[20:23], a[252:255], v[108:111], v[20:23]
    s_nop 5
    v_mov_b32_dpp v24, v16 quad_perm:[0,0,0,0] row_mask:0xf bank_mask:0xf
    v_mov_b32_dpp v28, v16 quad_perm:[1,1,1,1] row_mask:0xf bank_mask:0xf
    v_mov_b32_dpp v25, v17 quad_perm:[0,0,0,0] row_mask:0xf bank_mask:0xf
    v_mov_b32_dpp v29, v17 quad_perm:[1,1,1,1] row_mask:0xf bank_mask:0xf
    v_mov_b32_dpp v26, v18 quad_perm:[0,0,0,0] row_mask:0xf bank_mask:0xf
    v_mov_b32_dpp v30, v18 quad_perm:[1,1,1,1] row_mask:0xf bank_mask:0xf
    v_mov_b32_dpp v27, v19 quad_perm:[0,0,0,0] row_mask:0xf bank_mask:0xf
    v_mov_b32_dpp v31, v19 quad_perm:[1,1,1,1] row_mask:0xf bank_mask:0xf
    v_mov_b32_dpp v32, v20 quad_perm:[0,0,0,0] row_mask:0xf bank_mask:0xf
    v_mov_b32_dpp v36, v20 quad_perm:[1,1,1,1] row_mask:0xf bank_mask:0xf
    v_mov_b32_dpp v33, v21 quad_perm:[0,0,0,0] row_mask:0xf bank_mask:0xf
    v_mov_b32_dpp v37, v21 quad_perm:[1,1,1,1] row_mask:0xf bank_mask:0xf
    v_mov_b32_dpp v34, v22 quad_perm:[0,0,0,0] row_mask:0xf bank_mask:0xf
    v_mov_b32_dpp v38, v22 quad_perm:[1,1,1,1] row_mask:0xf bank_mask:0xf
    v_mov_b32_dpp v35, v23 quad_perm:[0,0,0,0] row_mask:0xf bank_mask:0xf
    v_mov_b32_dpp v39, v23 quad_perm:[1,1,1,1] row_mask:0xf bank_mask:0xf
    s_waitcnt vmcnt(8)
    s_barrier
    ds_read_b64_tr_b16 v[48:49], v40 offset:0
    ds_read_b64_tr_b16 v[50:51], v40 offset:512
    ds_read_b64_tr_b16 v[52:53], v41 offset:0
    ds_read_b64_tr_b16 v[54:55], v41 offset:512
    ds_read_b64_tr_b16 v[56:57], v226 offset:0
    ds_read_b64_tr_b16 v[58:59], v226 offset:512
    ds_read_b64_tr_b16 v[60:61], v227 offset:0
    ds_read_b64_tr_b16 v[62:63], v227 offset:512
    ds_read_b64_tr_b16 v[64:65], v40 offset:4096
    ds_read_b64_tr_b16 v[66:67], v40 offset:4608
    ds_read_b64_tr_b16 v[68:69], v41 offset:4096
    ds_read_b64_tr_b16 v[70:71], v41 offset:4608
    ds_read_b64_tr_b16 v[72:73], v226 offset:4096
    ds_read_b64_tr_b16 v[74:75], v226 offset:4608
    ds_read_b64_tr_b16 v[76:77], v227 offset:4096
    ds_read_b64_tr_b16 v[78:79], v227 offset:4608
    s_waitcnt lgkmcnt(12)
    s_waitcnt vmcnt(6)
    s_barrier
    ds_read_b64_tr_b16 v[172:173], v44 offset:0
    ds_read_b64_tr_b16 v[174:175], v44 offset:512
    ds_read_b64_tr_b16 v[176:177], v44 offset:4096
    ds_read_b64_tr_b16 v[178:179], v44 offset:4608
    v_mfma_f32_16x16x32_bf16 v[80:83], v[48:51], a[0:3], 0
    ds_read_b64_tr_b16 v[156:157], v40 offset:8192
    buffer_load_dwordx4 v231, s[4:7], m0 offen sc1 lds
    v_mfma_f32_16x16x32_bf16 v[84:87], v[48:51], a[64:67], 0
    ds_read_b64_tr_b16 v[158:159], v40 offset:8704
    v_mfma_f32_16x16x32_bf16 v[88:91], v[52:55], a[0:3], 0
    ds_read_b64_tr_b16 v[160:161], v41 offset:8192
    v_mfma_f32_16x16x32_bf16 v[92:95], v[52:55], a[64:67], 0
    ds_read_b64_tr_b16 v[162:163], v41 offset:8704
    s_waitcnt lgkmcnt(15)
    v_mfma_f32_16x16x32_bf16 v[96:99], v[56:59], a[0:3], 0
    ds_read_b64_tr_b16 v[164:165], v226 offset:8192
    s_add_u32 m0, m0, 4096
    v_mfma_f32_16x16x32_bf16 v[100:103], v[56:59], a[64:67], 0
    ds_read_b64_tr_b16 v[166:167], v226 offset:8704
    buffer_load_dwordx4 v231, s[4:7], m0 offen sc1 lds
    v_mfma_f32_16x16x32_bf16 v[104:107], v[60:63], a[0:3], 0
    ds_read_b64_tr_b16 v[168:169], v227 offset:8192
    v_mfma_f32_16x16x32_bf16 v[108:111], v[60:63], a[64:67], 0
    ds_read_b64_tr_b16 v[170:171], v227 offset:8704
    s_waitcnt lgkmcnt(15)
    s_waitcnt lgkmcnt(8)
    v_mfma_f32_16x16x32_bf16 v[144:147], v[172:175], v[172:175], 0
    s_add_u32 m0, m0, 4096
    v_mfma_f32_16x16x32_bf16 v[148:151], v[172:175], v[152:155], 0
    buffer_load_dwordx4 v231, s[4:7], m0 offen sc1 lds
    v_mfma_f32_16x16x32_bf16 v[144:147], v[176:179], v[176:179], v[144:147]
    v_mfma_f32_16x16x32_bf16 v[148:151], v[176:179], v[152:155], v[148:151]
    v_mfma_f32_16x16x32_bf16 v[80:83], v[64:67], a[4:7], v[80:83]
    ds_read_b64_tr_b16 v[48:49], v40 offset:12288
    ds_read_b64_tr_b16 v[240:241], v42 offset:0
    v_mfma_f32_16x16x32_bf16 v[84:87], v[64:67], a[68:71], v[84:87]
    ds_read_b64_tr_b16 v[50:51], v40 offset:12800
    ds_read_b64_tr_b16 v[242:243], v42 offset:2048
    v_mfma_f32_16x16x32_bf16 v[88:91], v[68:71], a[4:7], v[88:91]
    ds_read_b64_tr_b16 v[52:53], v41 offset:12288
    ds_read_b64_tr_b16 v[244:245], v42 offset:4096
    v_mfma_f32_16x16x32_bf16 v[92:95], v[68:71], a[68:71], v[92:95]
    ds_read_b64_tr_b16 v[54:55], v41 offset:12800
    ds_read_b64_tr_b16 v[246:247], v42 offset:6144
    v_mfma_f32_16x16x32_bf16 v[96:99], v[72:75], a[4:7], v[96:99]
    ds_read_b64_tr_b16 v[56:57], v226 offset:12288
    s_add_u32 m0, m0, 4096
    v_mfma_f32_16x16x32_bf16 v[100:103], v[72:75], a[68:71], v[100:103]
    ds_read_b64_tr_b16 v[58:59], v226 offset:12800
    buffer_load_dwordx4 v231, s[4:7], m0 offen sc1 lds
    v_mfma_f32_16x16x32_bf16 v[104:107], v[76:79], a[4:7], v[104:107]
    ds_read_b64_tr_b16 v[60:61], v227 offset:12288
    v_mfma_f32_16x16x32_bf16 v[108:111], v[76:79], a[68:71], v[108:111]
    ds_read_b64_tr_b16 v[62:63], v227 offset:12800
    s_waitcnt lgkmcnt(15)
    s_waitcnt vmcnt(7)
    s_barrier
    v_mfma_f32_16x16x32_bf16 v[80:83], v[156:159], a[8:11], v[80:83]
    ds_read_b64_tr_b16 v[64:65], v40 offset:16384
    v_cndmask_b32 v153, v144, v145, s[66:67]
    v_mfma_f32_16x16x32_bf16 v[84:87], v[156:159], a[72:75], v[84:87]
    ds_read_b64_tr_b16 v[66:67], v40 offset:16896
    v_cndmask_b32 v152, v148, v149, s[66:67]
    v_mfma_f32_16x16x32_bf16 v[88:91], v[160:163], a[8:11], v[88:91]
    ds_read_b64_tr_b16 v[68:69], v41 offset:16384
    v_cndmask_b32 v153, v153, v146, s[72:73]
    v_mfma_f32_16x16x32_bf16 v[92:95], v[160:163], a[72:75], v[92:95]
    ds_read_b64_tr_b16 v[70:71], v41 offset:16896
    s_waitcnt lgkmcnt(15)
    v_mfma_f32_16x16x32_bf16 v[96:99], v[164:167], a[8:11], v[96:99]
    ds_read_b64_tr_b16 v[72:73], v226 offset:16384
    v_cndmask_b32 v152, v152, v150, s[72:73]
    v_mfma_f32_16x16x32_bf16 v[100:103], v[164:167], a[72:75], v[100:103]
    ds_read_b64_tr_b16 v[74:75], v226 offset:16896
    v_cndmask_b32 v153, v153, v147, s[74:75]
    v_mfma_f32_16x16x32_bf16 v[104:107], v[168:171], a[8:11], v[104:107]
    ds_read_b64_tr_b16 v[76:77], v227 offset:16384
    v_cndmask_b32 v152, v152, v151, s[74:75]
    v_mfma_f32_16x16x32_bf16 v[108:111], v[168:171], a[72:75], v[108:111]
    ds_read_b64_tr_b16 v[78:79], v227 offset:16896
    s_waitcnt lgkmcnt(13)
    v_mfma_f32_16x16x32_bf16 v[80:83], v[48:51], a[12:15], v[80:83]
    ds_read_b64_tr_b16 v[156:157], v40 offset:20480
    v_max_f32 v153, 0, v153
    v_mfma_f32_16x16x32_bf16 v[84:87], v[48:51], a[76:79], v[84:87]
    ds_read_b64_tr_b16 v[158:159], v40 offset:20992
    s_mov_b64 exec, s[76:77]
    buffer_store_dwordx2 v[152:153], v230, s[4:7], s62 offen sc1
    s_mov_b64 exec, -1
    v_mfma_f32_16x16x32_bf16 v[88:91], v[52:55], a[12:15], v[88:91]
    ds_read_b64_tr_b16 v[160:161], v41 offset:20480
    v_mfma_f32_16x16x32_bf16 v[92:95], v[52:55], a[76:79], v[92:95]
    ds_read_b64_tr_b16 v[162:163], v41 offset:20992
    s_waitcnt lgkmcnt(12)
    v_mfma_f32_16x16x32_bf16 v[96:99], v[56:59], a[12:15], v[96:99]
    ds_read_b64_tr_b16 v[164:165], v226 offset:20480
    s_add_u32 m0, m0, 4096
    v_mfma_f32_16x16x32_bf16 v[100:103], v[56:59], a[76:79], v[100:103]
    ds_read_b64_tr_b16 v[166:167], v226 offset:20992
    buffer_load_dwordx4 v231, s[4:7], m0 offen sc1 lds
    v_mfma_f32_16x16x32_bf16 v[104:107], v[60:63], a[12:15], v[104:107]
    ds_read_b64_tr_b16 v[168:169], v227 offset:20480
    v_mfma_f32_16x16x32_bf16 v[108:111], v[60:63], a[76:79], v[108:111]
    ds_read_b64_tr_b16 v[170:171], v227 offset:20992
    s_waitcnt lgkmcnt(12)
    v_mfma_f32_16x16x32_bf16 v[80:83], v[64:67], a[16:19], v[80:83]
    ds_read_b64_tr_b16 v[48:49], v40 offset:24576
    s_add_u32 m0, m0, 4096
    v_mfma_f32_16x16x32_bf16 v[84:87], v[64:67], a[80:83], v[84:87]
    ds_read_b64_tr_b16 v[50:51], v40 offset:25088
    buffer_load_dwordx4 v231, s[4:7], m0 offen sc1 lds
    v_mfma_f32_16x16x32_bf16 v[88:91], v[68:71], a[16:19], v[88:91]
    ds_read_b64_tr_b16 v[52:53], v41 offset:24576
    v_mfma_f32_16x16x32_bf16 v[92:95], v[68:71], a[80:83], v[92:95]
    ds_read_b64_tr_b16 v[54:55], v41 offset:25088
    s_waitcnt lgkmcnt(12)
    v_mfma_f32_16x16x32_bf16 v[96:99], v[72:75], a[16:19], v[96:99]
    ds_read_b64_tr_b16 v[56:57], v226 offset:24576
    s_add_u32 m0, s90, 73728
    v_mfma_f32_16x16x32_bf16 v[100:103], v[72:75], a[80:83], v[100:103]
    ds_read_b64_tr_b16 v[58:59], v226 offset:25088
    v_add_u32 v228, 0, v207
    v_mfma_f32_16x16x32_bf16 v[104:107], v[76:79], a[16:19], v[104:107]
    ds_read_b64_tr_b16 v[60:61], v227 offset:24576
    buffer_load_dwordx4 v228, s[20:23], s32 offen lds
    v_mfma_f32_16x16x32_bf16 v[108:111], v[76:79], a[80:83], v[108:111]
    ds_read_b64_tr_b16 v[62:63], v227 offset:25088
    s_waitcnt lgkmcnt(12)
    s_waitcnt vmcnt(7)
    s_barrier
    v_mfma_f32_16x16x32_bf16 v[80:83], v[156:159], a[20:23], v[80:83]
    ds_read_b64_tr_b16 v[64:65], v40 offset:28672
    v_mfma_f32_16x16x32_bf16 v[84:87], v[156:159], a[84:87], v[84:87]
    ds_read_b64_tr_b16 v[66:67], v40 offset:29184
    s_add_u32 m0, m0, 1040
    v_mfma_f32_16x16x32_bf16 v[88:91], v[160:163], a[20:23], v[88:91]
    ds_read_b64_tr_b16 v[68:69], v41 offset:28672
    buffer_load_dwordx4 v228, s[20:23], s33 offen lds
    v_mfma_f32_16x16x32_bf16 v[92:95], v[160:163], a[84:87], v[92:95]
    ds_read_b64_tr_b16 v[70:71], v41 offset:29184
    s_waitcnt lgkmcnt(12)
    v_mfma_f32_16x16x32_bf16 v[96:99], v[164:167], a[20:23], v[96:99]
    ds_read_b64_tr_b16 v[72:73], v226 offset:28672
    v_mfma_f32_16x16x32_bf16 v[100:103], v[164:167], a[84:87], v[100:103]
    ds_read_b64_tr_b16 v[74:75], v226 offset:29184
    s_add_u32 m0, m0, 1040
    v_mfma_f32_16x16x32_bf16 v[104:107], v[168:171], a[20:23], v[104:107]
    ds_read_b64_tr_b16 v[76:77], v227 offset:28672
    buffer_load_dwordx4 v228, s[20:23], s34 offen lds
    v_mfma_f32_16x16x32_bf16 v[108:111], v[168:171], a[84:87], v[108:111]
    ds_read_b64_tr_b16 v[78:79], v227 offset:29184
    s_waitcnt lgkmcnt(12)
    v_mfma_f32_16x16x32_bf16 v[80:83], v[48:51], a[24:27], v[80:83]
    ds_read_b64_tr_b16 v[156:157], v40 offset:32768
    v_mfma_f32_16x16x32_bf16 v[84:87], v[48:51], a[88:91], v[84:87]
    ds_read_b64_tr_b16 v[158:159], v40 offset:33280
    s_add_u32 m0, m0, 1040
    v_mfma_f32_16x16x32_bf16 v[88:91], v[52:55], a[24:27], v[88:91]
    ds_read_b64_tr_b16 v[160:161], v41 offset:32768
    buffer_load_dwordx4 v228, s[20:23], s35 offen lds
    v_mfma_f32_16x16x32_bf16 v[92:95], v[52:55], a[88:91], v[92:95]
    ds_read_b64_tr_b16 v[162:163], v41 offset:33280
    s_waitcnt lgkmcnt(12)
    v_mfma_f32_16x16x32_bf16 v[96:99], v[56:59], a[24:27], v[96:99]
    ds_read_b64_tr_b16 v[164:165], v226 offset:32768
    v_mfma_f32_16x16x32_bf16 v[100:103], v[56:59], a[88:91], v[100:103]
    ds_read_b64_tr_b16 v[166:167], v226 offset:33280
    s_add_u32 m0, m0, 1040
    v_mfma_f32_16x16x32_bf16 v[104:107], v[60:63], a[24:27], v[104:107]
    ds_read_b64_tr_b16 v[168:169], v227 offset:32768
    buffer_load_dwordx4 v228, s[20:23], s36 offen lds
    v_mfma_f32_16x16x32_bf16 v[108:111], v[60:63], a[88:91], v[108:111]
    ds_read_b64_tr_b16 v[170:171], v227 offset:33280
    s_waitcnt lgkmcnt(12)
    v_mfma_f32_16x16x32_bf16 v[80:83], v[64:67], a[28:31], v[80:83]
    ds_read_b64_tr_b16 v[48:49], v40 offset:36864
    v_mfma_f32_16x16x32_bf16 v[84:87], v[64:67], a[92:95], v[84:87]
    ds_read_b64_tr_b16 v[50:51], v40 offset:37376
    s_add_u32 m0, m0, 1040
    v_mfma_f32_16x16x32_bf16 v[88:91], v[68:71], a[28:31], v[88:91]
    ds_read_b64_tr_b16 v[52:53], v41 offset:36864
    buffer_load_dwordx4 v228, s[20:23], s37 offen lds
    v_mfma_f32_16x16x32_bf16 v[92:95], v[68:71], a[92:95], v[92:95]
    ds_read_b64_tr_b16 v[54:55], v41 offset:37376
    s_waitcnt lgkmcnt(12)
    v_mfma_f32_16x16x32_bf16 v[96:99], v[72:75], a[28:31], v[96:99]
    ds_read_b64_tr_b16 v[56:57], v226 offset:36864
    v_mfma_f32_16x16x32_bf16 v[100:103], v[72:75], a[92:95], v[100:103]
    ds_read_b64_tr_b16 v[58:59], v226 offset:37376
    s_add_u32 m0, m0, 1040
    v_mfma_f32_16x16x32_bf16 v[104:107], v[76:79], a[28:31], v[104:107]
    ds_read_b64_tr_b16 v[60:61], v227 offset:36864
    buffer_load_dwordx4 v228, s[20:23], s38 offen lds
    v_mfma_f32_16x16x32_bf16 v[108:111], v[76:79], a[92:95], v[108:111]
    ds_read_b64_tr_b16 v[62:63], v227 offset:37376
    s_waitcnt lgkmcnt(12)
    v_mfma_f32_16x16x32_bf16 v[80:83], v[156:159], a[32:35], v[80:83]
    ds_read_b64_tr_b16 v[64:65], v40 offset:40960
    v_mfma_f32_16x16x32_bf16 v[84:87], v[156:159], a[96:99], v[84:87]
    ds_read_b64_tr_b16 v[66:67], v40 offset:41472
    s_add_u32 m0, m0, 1040
    v_mfma_f32_16x16x32_bf16 v[88:91], v[160:163], a[32:35], v[88:91]
    ds_read_b64_tr_b16 v[68:69], v41 offset:40960
    buffer_load_dwordx4 v228, s[20:23], s39 offen lds
    v_mfma_f32_16x16x32_bf16 v[92:95], v[160:163], a[96:99], v[92:95]
    ds_read_b64_tr_b16 v[70:71], v41 offset:41472
    s_waitcnt lgkmcnt(12)
    v_mfma_f32_16x16x32_bf16 v[96:99], v[164:167], a[32:35], v[96:99]
    ds_read_b64_tr_b16 v[72:73], v226 offset:40960
    v_mfma_f32_16x16x32_bf16 v[100:103], v[164:167], a[96:99], v[100:103]
    ds_read_b64_tr_b16 v[74:75], v226 offset:41472
    s_add_u32 m0, s90, 82048
    v_mfma_f32_16x16x32_bf16 v[104:107], v[168:171], a[32:35], v[104:107]
    ds_read_b64_tr_b16 v[76:77], v227 offset:40960
    v_add_u32 v228, 512, v207
    v_mfma_f32_16x16x32_bf16 v[108:111], v[168:171], a[96:99], v[108:111]
    ds_read_b64_tr_b16 v[78:79], v227 offset:41472
    s_waitcnt lgkmcnt(12)
    s_waitcnt vmcnt(8)
    s_barrier
    v_mfma_f32_16x16x32_bf16 v[80:83], v[48:51], a[36:39], v[80:83]
    ds_read_b64_tr_b16 v[156:157], v40 offset:45056
    buffer_load_dwordx2 v[210:211], v206, s[4:7], s94 offen offset:0 sc1
    v_mfma_f32_16x16x32_bf16 v[84:87], v[48:51], a[100:103], v[84:87]
    ds_read_b64_tr_b16 v[158:159], v40 offset:45568
    buffer_load_dwordx2 v[212:213], v206, s[4:7], s94 offen offset:512 sc1
    v_mfma_f32_16x16x32_bf16 v[88:91], v[52:55], a[36:39], v[88:91]
    ds_read_b64_tr_b16 v[160:161], v41 offset:45056
    buffer_load_dwordx2 v[214:215], v206, s[4:7], s94 offen offset:1024 sc1
    v_mfma_f32_16x16x32_bf16 v[92:95], v[52:55], a[100:103], v[92:95]
    ds_read_b64_tr_b16 v[162:163], v41 offset:45568
    s_waitcnt lgkmcnt(12)
    v_mfma_f32_16x16x32_bf16 v[96:99], v[56:59], a[36:39], v[96:99]
    ds_read_b64_tr_b16 v[164:165], v226 offset:45056
    buffer_load_dwordx2 v[216:217], v206, s[4:7], s94 offen offset:1536 sc1
    v_mfma_f32_16x16x32_bf16 v[100:103], v[56:59], a[100:103], v[100:103]
    ds_read_b64_tr_b16 v[166:167], v226 offset:45568
    buffer_load_dwordx2 v[218:219], v206, s[4:7], s94 offen offset:2048 sc1
    v_mfma_f32_16x16x32_bf16 v[104:107], v[60:63], a[36:39], v[104:107]
    ds_read_b64_tr_b16 v[168:169], v227 offset:45056
    buffer_load_dwordx2 v[220:221], v206, s[4:7], s94 offen offset:2560 sc1
    v_mfma_f32_16x16x32_bf16 v[108:111], v[60:63], a[100:103], v[108:111]
    ds_read_b64_tr_b16 v[170:171], v227 offset:45568
    s_waitcnt lgkmcnt(12)
    v_mfma_f32_16x16x32_bf16 v[80:83], v[64:67], a[40:43], v[80:83]
    ds_read_b64_tr_b16 v[48:49], v40 offset:49152
    buffer_load_dwordx2 v[222:223], v206, s[4:7], s94 offen offset:3072 sc1
    v_mfma_f32_16x16x32_bf16 v[84:87], v[64:67], a[104:107], v[84:87]
    ds_read_b64_tr_b16 v[50:51], v40 offset:49664
    buffer_load_dwordx2 v[224:225], v206, s[4:7], s94 offen offset:3584 sc1
    v_mfma_f32_16x16x32_bf16 v[88:91], v[68:71], a[40:43], v[88:91]
    ds_read_b64_tr_b16 v[52:53], v41 offset:49152
    v_mfma_f32_16x16x32_bf16 v[92:95], v[68:71], a[104:107], v[92:95]
    ds_read_b64_tr_b16 v[54:55], v41 offset:49664
    s_waitcnt lgkmcnt(12)
    v_mfma_f32_16x16x32_bf16 v[96:99], v[72:75], a[40:43], v[96:99]
    ds_read_b64_tr_b16 v[56:57], v226 offset:49152
    v_mfma_f32_16x16x32_bf16 v[100:103], v[72:75], a[104:107], v[100:103]
    ds_read_b64_tr_b16 v[58:59], v226 offset:49664
    buffer_load_dwordx4 v228, s[20:23], s32 offen lds
    v_mfma_f32_16x16x32_bf16 v[104:107], v[76:79], a[40:43], v[104:107]
    ds_read_b64_tr_b16 v[60:61], v227 offset:49152
    v_mfma_f32_16x16x32_bf16 v[108:111], v[76:79], a[104:107], v[108:111]
    ds_read_b64_tr_b16 v[62:63], v227 offset:49664
    s_waitcnt lgkmcnt(12)
    v_mfma_f32_16x16x32_bf16 v[80:83], v[156:159], a[44:47], v[80:83]
    ds_read_b64_tr_b16 v[64:65], v40 offset:53248
    s_add_u32 m0, m0, 1040
    v_mfma_f32_16x16x32_bf16 v[84:87], v[156:159], a[108:111], v[84:87]
    ds_read_b64_tr_b16 v[66:67], v40 offset:53760
    buffer_load_dwordx4 v228, s[20:23], s33 offen lds
    v_mfma_f32_16x16x32_bf16 v[88:91], v[160:163], a[44:47], v[88:91]
    ds_read_b64_tr_b16 v[68:69], v41 offset:53248
    v_mfma_f32_16x16x32_bf16 v[92:95], v[160:163], a[108:111], v[92:95]
    ds_read_b64_tr_b16 v[70:71], v41 offset:53760
    s_waitcnt lgkmcnt(12)
    v_mfma_f32_16x16x32_bf16 v[96:99], v[164:167], a[44:47], v[96:99]
    ds_read_b64_tr_b16 v[72:73], v226 offset:53248
    s_add_u32 m0, m0, 1040
    v_mfma_f32_16x16x32_bf16 v[100:103], v[164:167], a[108:111], v[100:103]
    ds_read_b64_tr_b16 v[74:75], v226 offset:53760
    buffer_load_dwordx4 v228, s[20:23], s34 offen lds
    v_mfma_f32_16x16x32_bf16 v[104:107], v[168:171], a[44:47], v[104:107]
    ds_read_b64_tr_b16 v[76:77], v227 offset:53248
    v_mfma_f32_16x16x32_bf16 v[108:111], v[168:171], a[108:111], v[108:111]
    ds_read_b64_tr_b16 v[78:79], v227 offset:53760
    s_waitcnt lgkmcnt(12)
    v_mfma_f32_16x16x32_bf16 v[80:83], v[48:51], a[48:51], v[80:83]
    ds_read_b64_tr_b16 v[156:157], v40 offset:57344
    s_add_u32 m0, m0, 1040
    v_mfma_f32_16x16x32_bf16 v[84:87], v[48:51], a[112:115], v[84:87]
    ds_read_b64_tr_b16 v[158:159], v40 offset:57856
    buffer_load_dwordx4 v228, s[20:23], s35 offen lds
    v_mfma_f32_16x16x32_bf16 v[88:91], v[52:55], a[48:51], v[88:91]
    ds_read_b64_tr_b16 v[160:161], v41 offset:57344
    v_mfma_f32_16x16x32_bf16 v[92:95], v[52:55], a[112:115], v[92:95]
    ds_read_b64_tr_b16 v[162:163], v41 offset:57856
    s_waitcnt lgkmcnt(12)
    v_mfma_f32_16x16x32_bf16 v[96:99], v[56:59], a[48:51], v[96:99]
    ds_read_b64_tr_b16 v[164:165], v226 offset:57344
    s_add_u32 m0, m0, 1040
    v_mfma_f32_16x16x32_bf16 v[100:103], v[56:59], a[112:115], v[100:103]
    ds_read_b64_tr_b16 v[166:167], v226 offset:57856
    buffer_load_dwordx4 v228, s[20:23], s36 offen lds
    v_mfma_f32_16x16x32_bf16 v[104:107], v[60:63], a[48:51], v[104:107]
    ds_read_b64_tr_b16 v[168:169], v227 offset:57344
    v_mfma_f32_16x16x32_bf16 v[108:111], v[60:63], a[112:115], v[108:111]
    ds_read_b64_tr_b16 v[170:171], v227 offset:57856
    s_waitcnt lgkmcnt(12)
    v_mfma_f32_16x16x32_bf16 v[80:83], v[64:67], a[52:55], v[80:83]
    ds_read_b64_tr_b16 v[48:49], v40 offset:61440
    s_add_u32 m0, m0, 1040
    v_mfma_f32_16x16x32_bf16 v[84:87], v[64:67], a[116:119], v[84:87]
    ds_read_b64_tr_b16 v[50:51], v40 offset:61952
    buffer_load_dwordx4 v228, s[20:23], s37 offen lds
    v_mfma_f32_16x16x32_bf16 v[88:91], v[68:71], a[52:55], v[88:91]
    ds_read_b64_tr_b16 v[52:53], v41 offset:61440
    v_mfma_f32_16x16x32_bf16 v[92:95], v[68:71], a[116:119], v[92:95]
    ds_read_b64_tr_b16 v[54:55], v41 offset:61952
    s_waitcnt lgkmcnt(12)
    v_mfma_f32_16x16x32_bf16 v[96:99], v[72:75], a[52:55], v[96:99]
    ds_read_b64_tr_b16 v[56:57], v226 offset:61440
    s_add_u32 m0, m0, 1040
    v_mfma_f32_16x16x32_bf16 v[100:103], v[72:75], a[116:119], v[100:103]
    ds_read_b64_tr_b16 v[58:59], v226 offset:61952
    buffer_load_dwordx4 v228, s[20:23], s38 offen lds
    v_mfma_f32_16x16x32_bf16 v[104:107], v[76:79], a[52:55], v[104:107]
    ds_read_b64_tr_b16 v[60:61], v227 offset:61440
    v_mfma_f32_16x16x32_bf16 v[108:111], v[76:79], a[116:119], v[108:111]
    ds_read_b64_tr_b16 v[62:63], v227 offset:61952
    s_waitcnt lgkmcnt(12)
    v_mfma_f32_16x16x32_bf16 v[80:83], v[156:159], a[56:59], v[80:83]
    s_add_u32 m0, m0, 1040
    v_mfma_f32_16x16x32_bf16 v[84:87], v[156:159], a[120:123], v[84:87]
    buffer_load_dwordx4 v228, s[20:23], s39 offen lds
    v_mfma_f32_16x16x32_bf16 v[88:91], v[160:163], a[56:59], v[88:91]
    v_mfma_f32_16x16x32_bf16 v[92:95], v[160:163], a[120:123], v[92:95]
    s_waitcnt lgkmcnt(8)
    v_mfma_f32_16x16x32_bf16 v[96:99], v[164:167], a[56:59], v[96:99]
    v_mfma_f32_16x16x32_bf16 v[100:103], v[164:167], a[120:123], v[100:103]
    v_mfma_f32_16x16x32_bf16 v[104:107], v[168:171], a[56:59], v[104:107]
    v_mfma_f32_16x16x32_bf16 v[108:111], v[168:171], a[120:123], v[108:111]
    s_waitcnt lgkmcnt(4)
    v_mfma_f32_16x16x32_bf16 v[80:83], v[48:51], a[60:63], v[80:83]
    v_mfma_f32_16x16x32_bf16 v[84:87], v[48:51], a[124:127], v[84:87]
    v_mfma_f32_16x16x32_bf16 v[88:91], v[52:55], a[60:63], v[88:91]
    v_mfma_f32_16x16x32_bf16 v[92:95], v[52:55], a[124:127], v[92:95]
    s_waitcnt lgkmcnt(0)
    v_mfma_f32_16x16x32_bf16 v[96:99], v[56:59], a[60:63], v[96:99]
    v_mfma_f32_16x16x32_bf16 v[100:103], v[56:59], a[124:127], v[100:103]
    v_mfma_f32_16x16x32_bf16 v[104:107], v[60:63], a[60:63], v[104:107]
    v_mfma_f32_16x16x32_bf16 v[108:111], v[60:63], a[124:127], v[108:111]
    s_waitcnt vmcnt(8)
    s_mov_b32 s54, 0
    s_mov_b32 s56, 0x3b000000
gac_25:
    v_max3_u32 v4, v211, v213, v215
    v_max3_u32 v5, v217, v219, v221
    v_max3_u32 v4, v4, v223, v225
    v_max_u32 v4, v4, v5
    v_cmp_eq_u32 vcc, -1, v4
    v_lshl_add_u32 v6, v1, 2, s95
    v_lshl_add_u32 v7, v3, 4, s95
    s_cbranch_vccnz ga_23
gax_24:
    s_nop 0
    v_pk_add_f32 v[210:211], v[210:211], v[212:213]
    v_pk_add_f32 v[214:215], v[214:215], v[216:217]
    v_pk_add_f32 v[218:219], v[218:219], v[220:221]
    v_pk_add_f32 v[222:223], v[222:223], v[224:225]
    v_pk_add_f32 v[210:211], v[210:211], v[214:215]
    v_pk_add_f32 v[218:219], v[218:219], v[222:223]
    v_pk_add_f32 v[4:5], v[210:211], v[218:219]
    v_pk_mul_f32 v[4:5], v[4:5], s[56:57] op_sel_hi:[1,0]
    v_fma_f32 v5, -v4, v4, v5
    v_max_f32_e64 v5, 0, v5
    v_add_f32 v5, 0x3727c5ac, v5
    v_rsq_f32 v5, v5
    s_nop 0
    v_mul_f32 v4, -v4, v5
    ds_write2st64_b32 v6, v5, v4 offset1:1
    v_lshl_add_u32 v6, v2, 2, s95
    s_waitcnt lgkmcnt(0)
    ds_read_b128 v[172:175], v7 offset:256
    ds_read_b128 v[156:159], v7 offset:0
    ds_read_b128 v[176:179], v7 offset:320
    ds_read_b128 v[160:163], v7 offset:64
    ds_read_b128 v[180:183], v7 offset:384
    ds_read_b128 v[164:167], v7 offset:128
    ds_read_b128 v[184:187], v7 offset:448
    ds_read_b128 v[168:171], v7 offset:192
    ds_read2_b32 v[188:189], v6 offset0:0 offset1:16
    ds_read2_b32 v[192:193], v6 offset0:64 offset1:80
    ds_read2_b32 v[190:191], v6 offset0:32 offset1:48
    ds_read2_b32 v[194:195], v6 offset0:96 offset1:112
    s_waitcnt lgkmcnt(10)
    v_pk_fma_f32 v[196:197], v[172:173], v[8:9], v[8:9] op_sel:[0,0,1] op_sel_hi:[1,0,1]
    s_add_u32 s85, s69, 131072
    s_mov_b64 exec, 0xffff
    buffer_load_dword v236, v229, s[20:23], s85 offen
    s_mov_b64 exec, -1
    s_nop 0
    v_pk_fma_f32 v[198:199], v[174:175], v[8:9], v[8:9] op_sel:[0,0,1] op_sel_hi:[1,0,1]
    v_pk_fma_f32 v[200:201], v[172:173], v[12:13], v[12:13] op_sel:[0,0,1] op_sel_hi:[1,0,1]
    v_pk_fma_f32 v[202:203], v[174:175], v[12:13], v[12:13] op_sel:[0,0,1] op_sel_hi:[1,0,1]
    v_pk_fma_f32 v[80:81], v[156:157], v[80:81], v[196:197]
    v_pk_fma_f32 v[82:83], v[158:159], v[82:83], v[198:199]
    v_pk_fma_f32 v[84:85], v[156:157], v[84:85], v[200:201]
    v_pk_fma_f32 v[86:87], v[158:159], v[86:87], v[202:203]
    s_waitcnt lgkmcnt(8)
    s_nop 0
    v_pk_fma_f32 v[196:197], v[176:177], v[8:9], v[8:9] op_sel:[0,0,1] op_sel_hi:[1,0,1]
    v_pk_fma_f32 v[198:199], v[178:179], v[8:9], v[8:9] op_sel:[0,0,1] op_sel_hi:[1,0,1]
    v_pk_fma_f32 v[200:201], v[176:177], v[12:13], v[12:13] op_sel:[0,0,1] op_sel_hi:[1,0,1]
    v_pk_fma_f32 v[202:203], v[178:179], v[12:13], v[12:13] op_sel:[0,0,1] op_sel_hi:[1,0,1]
    v_pk_fma_f32 v[88:89], v[160:161], v[88:89], v[196:197]
    v_pk_fma_f32 v[90:91], v[162:163], v[90:91], v[198:199]
    v_pk_fma_f32 v[92:93], v[160:161], v[92:93], v[200:201]
    v_pk_fma_f32 v[94:95], v[162:163], v[94:95], v[202:203]
    s_waitcnt lgkmcnt(6)
    v_pk_fma_f32 v[196:197], v[180:181], v[8:9], v[8:9] op_sel:[0,0,1] op_sel_hi:[1,0,1]
    s_add_u32 s85, s69, 196608
    s_mov_b64 exec, 0xffff
    buffer_load_dword v236, v229, s[20:23], s85 offen
    s_mov_b64 exec, -1
    v_pk_fma_f32 v[198:199], v[182:183], v[8:9], v[8:9] op_sel:[0,0,1] op_sel_hi:[1,0,1]
    v_pk_fma_f32 v[200:201], v[180:181], v[12:13], v[12:13] op_sel:[0,0,1] op_sel_hi:[1,0,1]
    v_pk_fma_f32 v[202:203], v[182:183], v[12:13], v[12:13] op_sel:[0,0,1] op_sel_hi:[1,0,1]
    v_pk_fma_f32 v[96:97], v[164:165], v[96:97], v[196:197]
    v_pk_fma_f32 v[98:99], v[166:167], v[98:99], v[198:199]
    v_pk_fma_f32 v[100:101], v[164:165], v[100:101], v[200:201]
    v_pk_fma_f32 v[102:103], v[166:167], v[102:103], v[202:203]
    s_waitcnt lgkmcnt(4)
    s_nop 0
    v_pk_fma_f32 v[196:197], v[184:185], v[8:9], v[8:9] op_sel:[0,0,1] op_sel_hi:[1,0,1]
    v_pk_fma_f32 v[198:199], v[186:187], v[8:9], v[8:9] op_sel:[0,0,1] op_sel_hi:[1,0,1]
    v_pk_fma_f32 v[200:201], v[184:185], v[12:13], v[12:13] op_sel:[0,0,1] op_sel_hi:[1,0,1]
    v_pk_fma_f32 v[202:203], v[186:187], v[12:13], v[12:13] op_sel:[0,0,1] op_sel_hi:[1,0,1]
    v_pk_fma_f32 v[104:105], v[168:169], v[104:105], v[196:197]
    v_pk_fma_f32 v[106:107], v[170:171], v[106:107], v[198:199]
    v_pk_fma_f32 v[108:109], v[168:169], v[108:109], v[200:201]
    v_pk_fma_f32 v[110:111], v[170:171], v[110:111], v[202:203]
    v_pk_mul_f32 v[196:197], v[80:81], v[80:81]
    v_pk_mul_f32 v[198:199], v[82:83], v[82:83]
    v_pk_mul_f32 v[200:201], v[84:85], v[84:85]
    v_pk_mul_f32 v[202:203], v[86:87], v[86:87]
    v_pk_fma_f32 v[196:197], v[196:197], s[58:59], v[46:47] op_sel_hi:[1,0,0]
    v_pk_fma_f32 v[198:199], v[198:199], s[58:59], v[46:47] op_sel_hi:[1,0,0]
    v_pk_fma_f32 v[200:201], v[200:201], s[58:59], v[46:47] op_sel_hi:[1,0,0]
    v_pk_fma_f32 v[202:203], v[202:203], s[58:59], v[46:47] op_sel_hi:[1,0,0]
    v_pk_mul_f32 v[196:197], v[196:197], v[80:81]
    v_pk_mul_f32 v[198:199], v[198:199], v[82:83]
    v_pk_mul_f32 v[200:201], v[200:201], v[84:85]
    v_pk_mul_f32 v[202:203], v[202:203], v[86:87]
    v_exp_f32 v196, v196
    v_exp_f32 v197, v197
    v_exp_f32 v198, v198
    v_exp_f32 v199, v199
    v_exp_f32 v200, v200
    v_exp_f32 v201, v201
    v_exp_f32 v202, v202
    v_exp_f32 v203, v203
    v_pk_add_f32 v[196:197], v[196:197], 1.0 op_sel_hi:[1,0]
    v_pk_add_f32 v[198:199], v[198:199], 1.0 op_sel_hi:[1,0]
    v_pk_add_f32 v[200:201], v[200:201], 1.0 op_sel_hi:[1,0]
    v_pk_add_f32 v[202:203], v[202:203], 1.0 op_sel_hi:[1,0]
    v_rcp_f32 v196, v196
    v_rcp_f32 v197, v197
    v_rcp_f32 v198, v198
    v_rcp_f32 v199, v199
    v_rcp_f32 v200, v200
    v_rcp_f32 v201, v201
    v_rcp_f32 v202, v202
    v_rcp_f32 v203, v203
    v_pk_mul_f32 v[80:81], v[80:81], v[196:197]
    v_pk_mul_f32 v[82:83], v[82:83], v[198:199]
    v_pk_mul_f32 v[84:85], v[84:85], v[200:201]
    v_pk_mul_f32 v[86:87], v[86:87], v[202:203]
    v_pk_mul_f32 v[196:197], v[88:89], v[88:89]
    v_pk_mul_f32 v[198:199], v[90:91], v[90:91]
    v_pk_mul_f32 v[200:201], v[92:93], v[92:93]
    v_pk_mul_f32 v[202:203], v[94:95], v[94:95]
    v_pk_fma_f32 v[196:197], v[196:197], s[58:59], v[46:47] op_sel_hi:[1,0,0]
    v_pk_fma_f32 v[198:199], v[198:199], s[58:59], v[46:47] op_sel_hi:[1,0,0]
    v_pk_fma_f32 v[200:201], v[200:201], s[58:59], v[46:47] op_sel_hi:[1,0,0]
    v_pk_fma_f32 v[202:203], v[202:203], s[58:59], v[46:47] op_sel_hi:[1,0,0]
    v_pk_mul_f32 v[196:197], v[196:197], v[88:89]
    v_pk_mul_f32 v[198:199], v[198:199], v[90:91]
    v_pk_mul_f32 v[200:201], v[200:201], v[92:93]
    v_pk_mul_f32 v[202:203], v[202:203], v[94:95]
    v_exp_f32 v196, v196
    v_exp_f32 v197, v197
    v_exp_f32 v198, v198
    v_exp_f32 v199, v199
    v_exp_f32 v200, v200
    v_exp_f32 v201, v201
    v_exp_f32 v202, v202
    v_exp_f32 v203, v203
    v_pk_add_f32 v[196:197], v[196:197], 1.0 op_sel_hi:[1,0]
    v_pk_add_f32 v[198:199], v[198:199], 1.0 op_sel_hi:[1,0]
    v_pk_add_f32 v[200:201], v[200:201], 1.0 op_sel_hi:[1,0]
    v_pk_add_f32 v[202:203], v[202:203], 1.0 op_sel_hi:[1,0]
    v_rcp_f32 v196, v196
    v_rcp_f32 v197, v197
    v_rcp_f32 v198, v198
    v_rcp_f32 v199, v199
    v_rcp_f32 v200, v200
    v_rcp_f32 v201, v201
    v_rcp_f32 v202, v202
    v_rcp_f32 v203, v203
    v_pk_mul_f32 v[88:89], v[88:89], v[196:197]
    v_pk_mul_f32 v[90:91], v[90:91], v[198:199]
    v_pk_mul_f32 v[92:93], v[92:93], v[200:201]
    v_pk_mul_f32 v[94:95], v[94:95], v[202:203]
    v_pk_mul_f32 v[196:197], v[96:97], v[96:97]
    v_pk_mul_f32 v[198:199], v[98:99], v[98:99]
    v_pk_mul_f32 v[200:201], v[100:101], v[100:101]
    v_pk_mul_f32 v[202:203], v[102:103], v[102:103]
    v_pk_fma_f32 v[196:197], v[196:197], s[58:59], v[46:47] op_sel_hi:[1,0,0]
    v_pk_fma_f32 v[198:199], v[198:199], s[58:59], v[46:47] op_sel_hi:[1,0,0]
    v_pk_fma_f32 v[200:201], v[200:201], s[58:59], v[46:47] op_sel_hi:[1,0,0]
    v_pk_fma_f32 v[202:203], v[202:203], s[58:59], v[46:47] op_sel_hi:[1,0,0]
    v_pk_mul_f32 v[196:197], v[196:197], v[96:97]
    v_pk_mul_f32 v[198:199], v[198:199], v[98:99]
    v_pk_mul_f32 v[200:201], v[200:201], v[100:101]
    v_pk_mul_f32 v[202:203], v[202:203], v[102:103]
    v_exp_f32 v196, v196
    v_exp_f32 v197, v197
    v_exp_f32 v198, v198
    v_exp_f32 v199, v199
    v_exp_f32 v200, v200
    v_exp_f32 v201, v201
    v_exp_f32 v202, v202
    v_exp_f32 v203, v203
    v_pk_add_f32 v[196:197], v[196:197], 1.0 op_sel_hi:[1,0]
    v_pk_add_f32 v[198:199], v[198:199], 1.0 op_sel_hi:[1,0]
    v_pk_add_f32 v[200:201], v[200:201], 1.0 op_sel_hi:[1,0]
    v_pk_add_f32 v[202:203], v[202:203], 1.0 op_sel_hi:[1,0]
    v_rcp_f32 v196, v196
    v_rcp_f32 v197, v197
    v_rcp_f32 v198, v198
    v_rcp_f32 v199, v199
    v_rcp_f32 v200, v200
    v_rcp_f32 v201, v201
    v_rcp_f32 v202, v202
    v_rcp_f32 v203, v203
    v_pk_mul_f32 v[96:97], v[96:97], v[196:197]
    v_pk_mul_f32 v[98:99], v[98:99], v[198:199]
    v_pk_mul_f32 v[100:101], v[100:101], v[200:201]
    v_pk_mul_f32 v[102:103], v[102:103], v[202:203]
    v_pk_mul_f32 v[196:197], v[104:105], v[104:105]
    v_pk_mul_f32 v[198:199], v[106:107], v[106:107]
    v_pk_mul_f32 v[200:201], v[108:109], v[108:109]
    v_pk_mul_f32 v[202:203], v[110:111], v[110:111]
    v_pk_fma_f32 v[196:197], v[196:197], s[58:59], v[46:47] op_sel_hi:[1,0,0]
    v_pk_fma_f32 v[198:199], v[198:199], s[58:59], v[46:47] op_sel_hi:[1,0,0]
    v_pk_fma_f32 v[200:201], v[200:201], s[58:59], v[46:47] op_sel_hi:[1,0,0]
    v_pk_fma_f32 v[202:203], v[202:203], s[58:59], v[46:47] op_sel_hi:[1,0,0]
    v_pk_mul_f32 v[196:197], v[196:197], v[104:105]
    v_pk_mul_f32 v[198:199], v[198:199], v[106:107]
    v_pk_mul_f32 v[200:201], v[200:201], v[108:109]
    v_pk_mul_f32 v[202:203], v[202:203], v[110:111]
    v_exp_f32 v196, v196
    v_exp_f32 v197, v197
    v_exp_f32 v198, v198
    v_exp_f32 v199, v199
    v_exp_f32 v200, v200
    v_exp_f32 v201, v201
    v_exp_f32 v202, v202
    v_exp_f32 v203, v203
    v_pk_add_f32 v[196:197], v[196:197], 1.0 op_sel_hi:[1,0]
    v_pk_add_f32 v[198:199], v[198:199], 1.0 op_sel_hi:[1,0]
    v_pk_add_f32 v[200:201], v[200:201], 1.0 op_sel_hi:[1,0]
    v_pk_add_f32 v[202:203], v[202:203], 1.0 op_sel_hi:[1,0]
    v_rcp_f32 v196, v196
    v_rcp_f32 v197, v197
    v_rcp_f32 v198, v198
    v_rcp_f32 v199, v199
    v_rcp_f32 v200, v200
    v_rcp_f32 v201, v201
    v_rcp_f32 v202, v202
    v_rcp_f32 v203, v203
    v_pk_mul_f32 v[104:105], v[104:105], v[196:197]
    v_pk_mul_f32 v[106:107], v[106:107], v[198:199]
    v_pk_mul_f32 v[108:109], v[108:109], v[200:201]
    v_pk_mul_f32 v[110:111], v[110:111], v[202:203]
    v_pk_mul_f32 v[172:173], v[80:81], v[80:81]
    v_pk_mul_f32 v[174:175], v[82:83], v[82:83]
    v_pk_mul_f32 v[176:177], v[88:89], v[88:89]
    v_pk_mul_f32 v[178:179], v[90:91], v[90:91]
    v_pk_mul_f32 v[180:181], v[96:97], v[96:97]
    v_pk_mul_f32 v[182:183], v[98:99], v[98:99]
    v_pk_mul_f32 v[184:185], v[104:105], v[104:105]
    v_pk_mul_f32 v[186:187], v[106:107], v[106:107]
    v_pk_add_f32 v[156:157], v[80:81], v[84:85]
    v_pk_add_f32 v[158:159], v[82:83], v[86:87]
    v_pk_add_f32 v[160:161], v[88:89], v[92:93]
    v_pk_add_f32 v[162:163], v[90:91], v[94:95]
    v_pk_add_f32 v[164:165], v[96:97], v[100:101]
    v_pk_add_f32 v[166:167], v[98:99], v[102:103]
    v_pk_add_f32 v[168:169], v[104:105], v[108:109]
    v_pk_add_f32 v[170:171], v[106:107], v[110:111]
    v_pk_fma_f32 v[172:173], v[84:85], v[84:85], v[172:173]
    v_pk_fma_f32 v[174:175], v[86:87], v[86:87], v[174:175]
    v_pk_fma_f32 v[176:177], v[92:93], v[92:93], v[176:177]
    v_pk_fma_f32 v[178:179], v[94:95], v[94:95], v[178:179]
    v_pk_fma_f32 v[180:181], v[100:101], v[100:101], v[180:181]
    v_pk_fma_f32 v[182:183], v[102:103], v[102:103], v[182:183]
    v_pk_fma_f32 v[184:185], v[108:109], v[108:109], v[184:185]
    v_pk_fma_f32 v[186:187], v[110:111], v[110:111], v[186:187]
    v_add_f32_dpp v156, v156, v156 row_ror:8 row_mask:0xf bank_mask:0x3
    v_add_f32_dpp v157, v157, v157 row_ror:8 row_mask:0xf bank_mask:0x3
    v_add_f32_dpp v158, v158, v158 row_ror:8 row_mask:0xf bank_mask:0x3
    v_add_f32_dpp v159, v159, v159 row_ror:8 row_mask:0xf bank_mask:0x3
    v_add_f32_dpp v160, v160, v160 row_ror:8 row_mask:0xf bank_mask:0x3
    v_add_f32_dpp v161, v161, v161 row_ror:8 row_mask:0xf bank_mask:0x3
    v_add_f32_dpp v162, v162, v162 row_ror:8 row_mask:0xf bank_mask:0x3
    v_add_f32_dpp v163, v163, v163 row_ror:8 row_mask:0xf bank_mask:0x3
    v_add_f32_dpp v164, v164, v164 row_ror:8 row_mask:0xf bank_mask:0x3
    v_add_f32_dpp v165, v165, v165 row_ror:8 row_mask:0xf bank_mask:0x3
    v_add_f32_dpp v166, v166, v166 row_ror:8 row_mask:0xf bank_mask:0x3
    v_add_f32_dpp v167, v167, v167 row_ror:8 row_mask:0xf bank_mask:0x3
    v_add_f32_dpp v168, v168, v168 row_ror:8 row_mask:0xf bank_mask:0x3
    v_add_f32_dpp v169, v169, v169 row_ror:8 row_mask:0xf bank_mask:0x3
    v_add_f32_dpp v170, v170, v170 row_ror:8 row_mask:0xf bank_mask:0x3
    v_add_f32_dpp v171, v171, v171 row_ror:8 row_mask:0xf bank_mask:0x3
    v_add_f32_dpp v156, v172, v172 row_ror:8 row_mask:0xf bank_mask:0xc
    v_add_f32_dpp v157, v173, v173 row_ror:8 row_mask:0xf bank_mask:0xc
    v_add_f32_dpp v158, v174, v174 row_ror:8 row_mask:0xf bank_mask:0xc
    v_add_f32_dpp v159, v175, v175 row_ror:8 row_mask:0xf bank_mask:0xc
    v_add_f32_dpp v160, v176, v176 row_ror:8 row_mask:0xf bank_mask:0xc
    v_add_f32_dpp v161, v177, v177 row_ror:8 row_mask:0xf bank_mask:0xc
    v_add_f32_dpp v162, v178, v178 row_ror:8 row_mask:0xf bank_mask:0xc
    v_add_f32_dpp v163, v179, v179 row_ror:8 row_mask:0xf bank_mask:0xc
    v_add_f32_dpp v164, v180, v180 row_ror:8 row_mask:0xf bank_mask:0xc
    v_add_f32_dpp v165, v181, v181 row_ror:8 row_mask:0xf bank_mask:0xc
    v_add_f32_dpp v166, v182, v182 row_ror:8 row_mask:0xf bank_mask:0xc
    v_add_f32_dpp v167, v183, v183 row_ror:8 row_mask:0xf bank_mask:0xc
    v_add_f32_dpp v168, v184, v184 row_ror:8 row_mask:0xf bank_mask:0xc
    v_add_f32_dpp v169, v185, v185 row_ror:8 row_mask:0xf bank_mask:0xc
    v_add_f32_dpp v170, v186, v186 row_ror:8 row_mask:0xf bank_mask:0xc
    v_add_f32_dpp v171, v187, v187 row_ror:8 row_mask:0xf bank_mask:0xc
    v_add_f32_dpp v156, v156, v156 row_half_mirror row_mask:0xf bank_mask:0x5
    v_add_f32_dpp v157, v157, v157 row_half_mirror row_mask:0xf bank_mask:0x5
    v_add_f32_dpp v158, v158, v158 row_half_mirror row_mask:0xf bank_mask:0x5
    v_add_f32_dpp v159, v159, v159 row_half_mirror row_mask:0xf bank_mask:0x5
    v_add_f32_dpp v160, v160, v160 row_half_mirror row_mask:0xf bank_mask:0x5
    v_add_f32_dpp v161, v161, v161 row_half_mirror row_mask:0xf bank_mask:0x5
    v_add_f32_dpp v162, v162, v162 row_half_mirror row_mask:0xf bank_mask:0x5
    v_add_f32_dpp v163, v163, v163 row_half_mirror row_mask:0xf bank_mask:0x5
    v_add_f32_dpp v156, v164, v164 row_half_mirror row_mask:0xf bank_mask:0xa
    v_add_f32_dpp v157, v165, v165 row_half_mirror row_mask:0xf bank_mask:0xa
    v_add_f32_dpp v158, v166, v166 row_half_mirror row_mask:0xf bank_mask:0xa
    v_add_f32_dpp v159, v167, v167 row_half_mirror row_mask:0xf bank_mask:0xa
    v_add_f32_dpp v160, v168, v168 row_half_mirror row_mask:0xf bank_mask:0xa
    v_add_f32_dpp v161, v169, v169 row_half_mirror row_mask:0xf bank_mask:0xa
    v_add_f32_dpp v162, v170, v170 row_half_mirror row_mask:0xf bank_mask:0xa
    v_add_f32_dpp v163, v171, v171 row_half_mirror row_mask:0xf bank_mask:0xa
    v_bfe_u32 v4, v2, 3, 1
    v_bfe_u32 v5, v2, 2, 1
    v_lshlrev_b32_e64 v4, 8, v4
    v_lshl_add_u32 v4, v5, 7, v4
    v_lshl_add_u32 v4, v3, 4, v4
    v_add_f32_dpp v156, v156, v156 quad_perm:[1,0,3,2] row_mask:0xf bank_mask:0xf
    v_add_f32_dpp v157, v157, v157 quad_perm:[1,0,3,2] row_mask:0xf bank_mask:0xf
    v_add_f32_dpp v158, v158, v158 quad_perm:[1,0,3,2] row_mask:0xf bank_mask:0xf
    v_add_f32_dpp v159, v159, v159 quad_perm:[1,0,3,2] row_mask:0xf bank_mask:0xf
    v_add_f32_dpp v160, v160, v160 quad_perm:[1,0,3,2] row_mask:0xf bank_mask:0xf
    v_add_f32_dpp v161, v161, v161 quad_perm:[1,0,3,2] row_mask:0xf bank_mask:0xf
    v_add_f32_dpp v162, v162, v162 quad_perm:[1,0,3,2] row_mask:0xf bank_mask:0xf
    v_add_f32_dpp v163, v163, v163 quad_perm:[1,0,3,2] row_mask:0xf bank_mask:0xf
    v_add_u32 v4, s95, v4
    v_lshlrev_b32 v5, 2, v1
    v_add_u32 v5, 158464, v5
    v_add_f32_dpp v156, v156, v156 quad_perm:[2,3,0,1] row_mask:0xf bank_mask:0xf
    v_add_f32_dpp v157, v157, v157 quad_perm:[2,3,0,1] row_mask:0xf bank_mask:0xf
    v_add_f32_dpp v158, v158, v158 quad_perm:[2,3,0,1] row_mask:0xf bank_mask:0xf
    v_add_f32_dpp v159, v159, v159 quad_perm:[2,3,0,1] row_mask:0xf bank_mask:0xf
    v_add_f32_dpp v160, v160, v160 quad_perm:[2,3,0,1] row_mask:0xf bank_mask:0xf
    v_add_f32_dpp v161, v161, v161 quad_perm:[2,3,0,1] row_mask:0xf bank_mask:0xf
    v_add_f32_dpp v162, v162, v162 quad_perm:[2,3,0,1] row_mask:0xf bank_mask:0xf
    v_add_f32_dpp v163, v163, v163 quad_perm:[2,3,0,1] row_mask:0xf bank_mask:0xf
    v_add_u32 v4, -2048, v4
    s_mov_b32 exec_lo, 0x11111111
    s_mov_b32 exec_hi, 0x11111111
    ds_write_b128 v4, v[156:159]
    ds_write_b128 v4, v[160:163] offset:64
    s_mov_b64 exec, -1
    s_cmp_eq_u32 s50, 3
    s_waitcnt lgkmcnt(0)
    s_barrier
    s_cbranch_scc0 L_26
    ds_read2st64_b32 v[172:173], v5 offset0:0 offset1:1
    ds_read2st64_b32 v[174:175], v5 offset0:2 offset1:3
    ds_read2st64_b32 v[176:177], v5 offset0:4 offset1:5
    ds_read2st64_b32 v[178:179], v5 offset0:6 offset1:7
    s_waitcnt lgkmcnt(0)
    v_pk_add_f32 v[172:173], v[172:173], v[174:175]
    v_pk_add_f32 v[176:177], v[176:177], v[178:179]
    v_pk_add_f32 v[172:173], v[172:173], v[176:177]
    v_max_f32 v173, 0, v173
    buffer_store_dwordx2 v[172:173], v206, s[4:7], s61 offen sc1
L_26:
    s_waitcnt vmcnt(10)
    ds_read_b64 a[0:1], v204 offset:0
    ds_read_b64 a[2:3], v204 offset:32
    ds_read_b64 a[4:5], v204 offset:64
    ds_read_b64 a[6:7], v204 offset:96
    ds_read_b64 a[8:9], v205 offset:128
    ds_read_b64 a[10:11], v205 offset:160
    ds_read_b64 a[12:13], v205 offset:192
    ds_read_b64 a[14:15], v205 offset:224
    ds_read_b64 a[16:17], v204 offset:256
    ds_read_b64 a[18:19], v204 offset:288
    ds_read_b64 a[20:21], v204 offset:320
    ds_read_b64 a[22:23], v204 offset:352
    ds_read_b64 a[24:25], v205 offset:384
    ds_read_b64 a[26:27], v205 offset:416
    ds_read_b64 a[28:29], v205 offset:448
    ds_read_b64 a[30:31], v205 offset:480
    s_waitcnt vmcnt(2)
    ds_read_b64 a[32:33], v204 offset:8320
    ds_read_b64 a[34:35], v204 offset:8352
    ds_read_b64 a[36:37], v204 offset:8384
    ds_read_b64 a[38:39], v204 offset:8416
    ds_read_b64 a[40:41], v205 offset:8448
    ds_read_b64 a[42:43], v205 offset:8480
    ds_read_b64 a[44:45], v205 offset:8512
    ds_read_b64 a[46:47], v205 offset:8544
    ds_read_b64 a[48:49], v204 offset:8576
    ds_read_b64 a[50:51], v204 offset:8608
    ds_read_b64 a[52:53], v204 offset:8640
    ds_read_b64 a[54:55], v204 offset:8672
    ds_read_b64 a[56:57], v205 offset:8704
    ds_read_b64 a[58:59], v205 offset:8736
    ds_read_b64 a[60:61], v205 offset:8768
    ds_read_b64 a[62:63], v205 offset:8800
    s_lshl_b32 s65, s51, 7
    v_lshl_add_u32 v4, v2, 1, s65
    v_lshlrev_b32_e64 v5, 3, v3
    v_add_u32 v5, 155648, v5
    ds_read_b64 v[248:249], v5 offset:0
    ds_read_b64 v[250:251], v5 offset:32
    ds_read_b64 v[252:253], v5 offset:64
    ds_read_b64 v[254:255], v5 offset:96
    s_waitcnt lgkmcnt(15)
    s_add_u32 s53, s83, 2
    global_load_ushort v8, v4, s[44:45] offset:0
    s_mul_i32 s55, s52, 458752
    s_lshl_b32 s56, s50, 14
    s_add_u32 s55, s55, s56
    s_add_u32 s55, s55, 9437184
    s_cmp_ge_u32 s53, 7
    s_cselect_b32 s56, 7, 0
    s_sub_u32 s53, s53, s56
    s_lshl_b32 s8, s53, 16
    s_add_u32 s8, s8, s55
    s_add_u32 s53, s53, 1
    global_load_ushort v9, v4, s[44:45] offset:32
    s_cmp_ge_u32 s53, 7
    s_cselect_b32 s56, 7, 0
    s_sub_u32 s53, s53, s56
    s_lshl_b32 s9, s53, 16
    s_add_u32 s9, s9, s55
    s_add_u32 s53, s53, 1
    s_cmp_ge_u32 s53, 7
    s_cselect_b32 s56, 7, 0
    s_sub_u32 s53, s53, s56
    s_lshl_b32 s10, s53, 16
    global_load_ushort v10, v4, s[44:45] offset:64
    s_add_u32 s10, s10, s55
    s_add_u32 s53, s53, 1
    s_cmp_ge_u32 s53, 7
    s_cselect_b32 s56, 7, 0
    s_sub_u32 s53, s53, s56
    s_lshl_b32 s11, s53, 16
    s_add_u32 s11, s11, s55
    s_add_u32 s53, s53, 1
    s_cmp_ge_u32 s53, 7
    s_cselect_b32 s56, 7, 0
    global_load_ushort v11, v4, s[44:45] offset:96
    s_sub_u32 s53, s53, s56
    s_lshl_b32 s12, s53, 16
    s_add_u32 s12, s12, s55
    s_add_u32 s53, s53, 1
    s_cmp_ge_u32 s53, 7
    s_cselect_b32 s56, 7, 0
    s_sub_u32 s53, s53, s56
    s_lshl_b32 s13, s53, 16
    s_add_u32 s13, s13, s55
    s_add_u32 s53, s53, 1
    s_add_u32 m0, s90, 73728
    v_add_u32 v228, 65536, v207
    buffer_load_dwordx4 v228, s[20:23], s32 offen lds
    s_add_u32 m0, m0, 1040
    s_cmp_ge_u32 s53, 7
    s_cselect_b32 s56, 7, 0
    s_sub_u32 s53, s53, s56
    s_lshl_b32 s14, s53, 16
    s_add_u32 s14, s14, s55
    s_add_u32 s53, s53, 1
    s_mul_i32 s15, s50, 24576
    s_add_u32 s15, s15, 65536
    s_lshl_b32 s16, s52, 7
    s_mul_i32 s56, s50, 98304
    buffer_load_dwordx4 v228, s[20:23], s33 offen lds
    s_add_u32 m0, m0, 1040
    s_add_u32 s70, s16, s56
    s_add_u32 s70, s70, 524288
    s_mul_i32 s71, s50, 12288
    s_add_u32 s71, s71, 65536
    s_mul_i32 s56, s50, 131072
    s_add_u32 s16, s16, s56
    s_lshl_b32 s17, s50, 14
    s_add_u32 s53, s50, 1
    s_and_b32 s53, s53, 3
    s_and_b32 s57, s52, 1
    buffer_load_dwordx4 v228, s[20:23], s34 offen lds
    s_add_u32 m0, m0, 1040
    s_lshl_b32 s56, s53, 1
    s_add_u32 s56, s56, s57
    s_cmp_eq_u32 s53, 3
    s_cselect_b32 s57, 1, 0
    s_sub_u32 s56, s56, s57
    s_add_u32 s57, s83, 12
    s_sub_u32 s57, s57, s56
    s_mul_i32 s55, s57, 37
    s_lshr_b32 s55, s55, 8
    s_mul_i32 s55, s55, 7
    buffer_load_dwordx4 v228, s[20:23], s35 offen lds
    s_add_u32 m0, m0, 1040
    s_sub_u32 s57, s57, s55
    s_add_u32 s55, s57, 1
    s_cmp_eq_u32 s55, 7
    s_cselect_b32 s55, 0, s55
    s_min_u32 s57, s57, 5
    s_mul_i32 s53, s53, 24576
    s_add_u32 s53, s53, 65536
    s_lshl_b32 s57, s57, 12
    s_lshl_b32 s55, s55, 12
    s_add_u32 s18, s57, s53
    buffer_load_dwordx4 v228, s[20:23], s36 offen lds
    s_add_u32 m0, m0, 1040
    s_add_u32 s19, s55, s53
    s_add_u32 s53, s50, 2
    s_and_b32 s53, s53, 3
    s_and_b32 s57, s52, 1
    s_lshl_b32 s56, s53, 1
    s_add_u32 s56, s56, s57
    s_cmp_eq_u32 s53, 3
    s_cselect_b32 s57, 1, 0
    s_sub_u32 s56, s56, s57
    s_add_u32 s57, s83, 12
    buffer_load_dwordx4 v228, s[20:23], s37 offen lds
    s_add_u32 m0, m0, 1040
    s_sub_u32 s57, s57, s56
    s_mul_i32 s55, s57, 37
    s_lshr_b32 s55, s55, 8
    s_mul_i32 s55, s55, 7
    s_sub_u32 s57, s57, s55
    s_add_u32 s55, s57, 1
    s_cmp_eq_u32 s55, 7
    s_cselect_b32 s55, 0, s55
    s_min_u32 s57, s57, 5
    s_mul_i32 s53, s53, 24576
    buffer_load_dwordx4 v228, s[20:23], s38 offen lds
    s_add_u32 m0, m0, 1040
    s_add_u32 s53, s53, 65536
    s_lshl_b32 s57, s57, 12
    s_lshl_b32 s55, s55, 12
    s_add_u32 s40, s57, s53
    s_add_u32 s41, s55, s53
    s_add_u32 s53, s50, 3
    s_and_b32 s53, s53, 3
    s_and_b32 s57, s52, 1
    s_lshl_b32 s56, s53, 1
    s_add_u32 s56, s56, s57
    buffer_load_dwordx4 v228, s[20:23], s39 offen lds
    s_cmp_eq_u32 s53, 3
    s_cselect_b32 s57, 1, 0
    s_sub_u32 s56, s56, s57
    s_add_u32 s57, s83, 12
    s_sub_u32 s57, s57, s56
    s_mul_i32 s55, s57, 37
    s_lshr_b32 s55, s55, 8
    s_mul_i32 s55, s55, 7
    s_sub_u32 s57, s57, s55
    buffer_load_dwordx2 v[210:211], v206, s[4:7], s60 offen offset:0 sc1
    buffer_load_dwordx2 v[212:213], v206, s[4:7], s60 offen offset:512 sc1
    buffer_load_dwordx2 v[214:215], v206, s[4:7], s60 offen offset:1024 sc1
    buffer_load_dwordx2 v[216:217], v206, s[4:7], s60 offen offset:1536 sc1
    buffer_load_dwordx2 v[218:219], v206, s[4:7], s60 offen offset:2048 sc1
    buffer_load_dwordx2 v[220:221], v206, s[4:7], s60 offen offset:2560 sc1
    buffer_load_dwordx2 v[222:223], v206, s[4:7], s60 offen offset:3072 sc1
    buffer_load_dwordx2 v[224:225], v206, s[4:7], s60 offen offset:3584 sc1
    s_waitcnt lgkmcnt(0)
    s_add_u32 s55, s57, 1
    s_cmp_eq_u32 s55, 7
    s_cselect_b32 s55, 0, s55
    s_min_u32 s57, s57, 5
    s_mul_i32 s53, s53, 24576
    s_add_u32 s53, s53, 65536
    s_lshl_b32 s57, s57, 12
    s_lshl_b32 s55, s55, 12
    s_add_u32 s42, s57, s53
    s_add_u32 s43, s55, s53
    s_mul_i32 s53, s52, 7
    s_add_u32 s53, s53, s84
    s_add_u32 m0, s90, 82048
    v_add_u32 v228, 66048, v207
    buffer_load_dwordx4 v228, s[20:23], s32 offen lds
    s_add_u32 m0, m0, 1040
    s_lshr_b32 s53, s53, 1
    s_mul_i32 s56, s51, 112
    s_add_u32 s53, s53, s56
    s_lshl_b32 s53, s53, 10
    s_add_u32 s53, s53, 13631488
    s_lshl_b32 s57, s51, 5
    s_add_u32 s57, s57, s52
    s_lshl_b32 s57, s57, 9
    s_add_u32 s57, s57, 17301504
    s_mov_b32 s56, 28672
    buffer_load_dwordx4 v228, s[20:23], s33 offen lds
    s_add_u32 m0, m0, 1040
    s_cmp_eq_u32 s50, 3
    s_cselect_b32 s46, s57, s53
    s_cselect_b32 s56, 4096, s56
    s_cselect_b32 s78, 0, 1.0
    s_add_u32 s47, s46, s56
    s_add_u32 s0, s47, s56
    s_add_u32 s1, s0, s56
    s_lshl_b32 s53, s52, 2
    s_lshr_b32 s56, s51, 3
    s_add_u32 s79, s53, s56
    buffer_load_dwordx4 v228, s[20:23], s34 offen lds
    s_add_u32 m0, m0, 1040
    s_add_u32 s79, s79, 128
    s_add_u32 s53, s53, s50
    s_lshr_b32 s56, s51, 3
    s_lshl_b32 s56, s56, 5
    s_add_u32 s53, s53, s56
    s_add_u32 s53, s53, 128
    s_lshl_b32 s80, s53, 7
    s_lshr_b32 s53, s52, 2
    s_lshl_b32 s53, s53, 5
    s_add_u32 s53, s53, s51
    buffer_load_dwordx4 v228, s[20:23], s35 offen lds
    s_add_u32 m0, m0, 1040
    s_add_u32 s53, s53, 256
    s_lshl_b32 s81, s53, 7
    s_lshl_b32 s88, s51, 2
    s_add_u32 s88, s88, s50
    s_lshl_b32 s89, s88, 12
    s_add_u32 s89, s89, 17301504
    s_lshl_b32 s91, s88, 14
    s_lshl_b32 s56, s52, 7
    s_add_u32 s91, s91, s56
    s_mul_i32 s88, s88, 28672
    buffer_load_dwordx4 v228, s[20:23], s36 offen lds
    s_add_u32 m0, m0, 1040
    s_add_u32 s88, s88, 13631488
    s_lshl_b32 s65, s51, 7
    s_and_b32 s56, s51, 7
    s_lshl_b32 s56, s56, 2
    s_add_u32 s56, s56, s50
    s_mul_i32 s56, s56, 28672
    s_lshl_b32 s96, s52, 7
    s_add_u32 s96, s96, s56
    buffer_load_dwordx4 v228, s[20:23], s37 offen lds
    s_add_u32 m0, m0, 1040
    s_nop 0
    buffer_load_dwordx4 v228, s[20:23], s38 offen lds
    s_add_u32 m0, m0, 1040
    s_nop 0
    buffer_load_dwordx4 v228, s[20:23], s39 offen lds
    s_mov_b32 s100, s55
    s_mov_b32 s101, s56
    s_waitcnt vmcnt(8)
    s_mov_b32 s54, 0
    s_mov_b32 s56, 0x3a924925
gac_29:
    v_max3_u32 v4, v211, v213, v215
    v_max3_u32 v5, v217, v219, v221
    v_max3_u32 v4, v4, v223, v225
    v_max_u32_e64 v4, v4, v5
    v_cmp_eq_u32 vcc, -1, v4
    v_lshl_add_u32 v6, v1, 2, s95
    v_lshl_add_u32 v7, v3, 4, s95
    s_cbranch_vccnz ga_27
gax_28:
    s_nop 0
    v_pk_add_f32 v[210:211], v[210:211], v[212:213]
    v_pk_add_f32 v[214:215], v[214:215], v[216:217]
    v_pk_add_f32 v[218:219], v[218:219], v[220:221]
    v_pk_add_f32 v[222:223], v[222:223], v[224:225]
    v_pk_add_f32 v[210:211], v[210:211], v[214:215]
    v_pk_add_f32 v[218:219], v[218:219], v[222:223]
    v_pk_add_f32 v[4:5], v[210:211], v[218:219]
    v_pk_mul_f32 v[4:5], v[4:5], s[56:57] op_sel_hi:[1,0]
    v_fma_f32 v5, -v4, v4, v5
    v_max_f32_e64 v5, 0, v5
    v_add_f32 v5, 0x3727c5ac, v5
    v_rsq_f32 v5, v5
    s_nop 0
    v_mul_f32 v4, -v4, v5
    ds_write2st64_b32 v6, v5, v4 offset1:1
    v_lshl_add_u32 v6, v2, 2, s95
    s_waitcnt lgkmcnt(0)
    ds_read_b128 v[172:175], v7 offset:256
    ds_read_b128 v[156:159], v7 offset:0
    ds_read_b128 v[176:179], v7 offset:320
    ds_read_b128 v[160:163], v7 offset:64
    ds_read_b128 v[180:183], v7 offset:384
    ds_read_b128 v[164:167], v7 offset:128
    ds_read_b128 v[184:187], v7 offset:448
    ds_read_b128 v[168:171], v7 offset:192
    s_waitcnt lgkmcnt(6)
    v_pk_fma_f32 v[80:81], v[80:81], v[156:157], v[172:173]
    v_pk_fma_f32 v[82:83], v[82:83], v[158:159], v[174:175]
    v_pk_fma_f32 v[84:85], v[84:85], v[156:157], v[172:173]
    v_pk_fma_f32 v[86:87], v[86:87], v[158:159], v[174:175]
    v_cvt_pk_bf16_f32 v210, v80, v81
    v_cvt_pk_bf16_f32 v211, v82, v83
    v_cvt_pk_bf16_f32 v218, v84, v85
    v_cvt_pk_bf16_f32 v219, v86, v87
    s_waitcnt lgkmcnt(4)
    s_nop 0
    v_pk_fma_f32 v[88:89], v[88:89], v[160:161], v[176:177]
    v_pk_fma_f32 v[90:91], v[90:91], v[162:163], v[178:179]
    v_pk_fma_f32 v[92:93], v[92:93], v[160:161], v[176:177]
    v_pk_fma_f32 v[94:95], v[94:95], v[162:163], v[178:179]
    v_cvt_pk_bf16_f32 v212, v88, v89
    v_cvt_pk_bf16_f32 v213, v90, v91
    v_cvt_pk_bf16_f32 v220, v92, v93
    v_cvt_pk_bf16_f32 v221, v94, v95
    buffer_store_dwordx4 v[210:213], v47, s[4:7], s63 offen offset:0 sc1
    buffer_store_dwordx4 v[218:221], v47, s[4:7], s64 offen offset:0 sc1
    s_waitcnt lgkmcnt(2)
    s_nop 0
    v_pk_fma_f32 v[96:97], v[96:97], v[164:165], v[180:181]
    v_pk_fma_f32 v[98:99], v[98:99], v[166:167], v[182:183]
    v_pk_fma_f32 v[100:101], v[100:101], v[164:165], v[180:181]
    v_pk_fma_f32 v[102:103], v[102:103], v[166:167], v[182:183]
    v_cvt_pk_bf16_f32 v214, v96, v97
    v_cvt_pk_bf16_f32 v215, v98, v99
    v_cvt_pk_bf16_f32 v222, v100, v101
    v_cvt_pk_bf16_f32 v223, v102, v103
    s_waitcnt lgkmcnt(0)
    s_nop 0
    v_pk_fma_f32 v[104:105], v[104:105], v[168:169], v[184:185]
    v_pk_fma_f32 v[106:107], v[106:107], v[170:171], v[186:187]
    v_pk_fma_f32 v[108:109], v[108:109], v[168:169], v[184:185]
    v_pk_fma_f32 v[110:111], v[110:111], v[170:171], v[186:187]
    v_cvt_pk_bf16_f32 v216, v104, v105
    v_cvt_pk_bf16_f32 v217, v106, v107
    v_cvt_pk_bf16_f32 v224, v108, v109
    v_cvt_pk_bf16_f32 v225, v110, v111
    buffer_store_dwordx4 v[214:217], v47, s[4:7], s63 offen offset:1024 sc1
    buffer_store_dwordx4 v[222:225], v47, s[4:7], s64 offen offset:1024 sc1
    s_lshl_b32 s79, s52, 2
    s_lshr_b32 s56, s51, 3
    s_add_u32 s79, s79, s56
    s_add_u32 s79, s79, 128
    s_lshl_b32 s68, s79, 7
    v_mul_u32_u24 v6, 4096, v1
    v_mov_b32 v7, 1
    ds_read_b64_tr_b16 v[48:49], v40 offset:0
    ds_read_b64_tr_b16 v[50:51], v40 offset:512
    ds_read_b64_tr_b16 v[52:53], v41 offset:0
    ds_read_b64_tr_b16 v[54:55], v41 offset:512
    ds_read_b64_tr_b16 v[56:57], v226 offset:0
    ds_read_b64_tr_b16 v[58:59], v226 offset:512
    ds_read_b64_tr_b16 v[60:61], v227 offset:0
    ds_read_b64_tr_b16 v[62:63], v227 offset:512
    ds_read_b64_tr_b16 v[64:65], v40 offset:4096
    ds_read_b64_tr_b16 v[66:67], v40 offset:4608
    ds_read_b64_tr_b16 v[68:69], v41 offset:4096
    ds_read_b64_tr_b16 v[70:71], v41 offset:4608
    ds_read_b64_tr_b16 v[72:73], v226 offset:4096
    ds_read_b64_tr_b16 v[74:75], v226 offset:4608
    ds_read_b64_tr_b16 v[76:77], v227 offset:4096
    ds_read_b64_tr_b16 v[78:79], v227 offset:4608
    s_waitcnt lgkmcnt(12)
    s_waitcnt vmcnt(12)
    v_mfma_f32_16x16x32_bf16 v[112:115], a[128:131], v[48:51], 0
    ds_read_b64_tr_b16 v[156:157], v40 offset:8192
    ds_read_b64 a[64:65], v204 offset:0
    v_mfma_f32_16x16x32_bf16 v[116:119], a[192:195], v[48:51], 0
    ds_read_b64_tr_b16 v[158:159], v40 offset:8704
    ds_read_b64 a[66:67], v204 offset:32
    v_mfma_f32_16x16x32_bf16 v[120:123], a[128:131], v[52:55], 0
    ds_read_b64_tr_b16 v[160:161], v41 offset:8192
    ds_read_b64 a[68:69], v204 offset:64
    v_mfma_f32_16x16x32_bf16 v[124:127], a[192:195], v[52:55], 0
    ds_read_b64_tr_b16 v[162:163], v41 offset:8704
    s_waitcnt lgkmcnt(15)
    v_mfma_f32_16x16x32_bf16 v[128:131], a[128:131], v[56:59], 0
    ds_read_b64_tr_b16 v[164:165], v226 offset:8192
    ds_read_b64 a[70:71], v204 offset:96
    v_mfma_f32_16x16x32_bf16 v[132:135], a[192:195], v[56:59], 0
    ds_read_b64_tr_b16 v[166:167], v226 offset:8704
    ds_read_b64 a[72:73], v205 offset:128
    v_mfma_f32_16x16x32_bf16 v[136:139], a[128:131], v[60:63], 0
    ds_read_b64_tr_b16 v[168:169], v227 offset:8192
    ds_read_b64 a[74:75], v205 offset:160
    v_mfma_f32_16x16x32_bf16 v[140:143], a[192:195], v[60:63], 0
    ds_read_b64_tr_b16 v[170:171], v227 offset:8704
    s_waitcnt lgkmcnt(15)
    v_mfma_f32_16x16x32_bf16 v[112:115], a[132:135], v[64:67], v[112:115]
    ds_read_b64_tr_b16 v[48:49], v40 offset:12288
    ds_read_b64 a[76:77], v205 offset:192
    v_mfma_f32_16x16x32_bf16 v[116:119], a[196:199], v[64:67], v[116:119]
    ds_read_b64_tr_b16 v[50:51], v40 offset:12800
    ds_read_b64 a[78:79], v205 offset:224
    v_mfma_f32_16x16x32_bf16 v[120:123], a[132:135], v[68:71], v[120:123]
    ds_read_b64_tr_b16 v[52:53], v41 offset:12288
    ds_read_b64 a[80:81], v204 offset:256
    v_mfma_f32_16x16x32_bf16 v[124:127], a[196:199], v[68:71], v[124:127]
    ds_read_b64_tr_b16 v[54:55], v41 offset:12800
    s_waitcnt lgkmcnt(15)
    v_mfma_f32_16x16x32_bf16 v[128:131], a[132:135], v[72:75], v[128:131]
    ds_read_b64_tr_b16 v[56:57], v226 offset:12288
    ds_read_b64 a[82:83], v204 offset:288
    v_mfma_f32_16x16x32_bf16 v[132:135], a[196:199], v[72:75], v[132:135]
    ds_read_b64_tr_b16 v[58:59], v226 offset:12800
    ds_read_b64 a[84:85], v204 offset:320
    v_mfma_f32_16x16x32_bf16 v[136:139], a[132:135], v[76:79], v[136:139]
    ds_read_b64_tr_b16 v[60:61], v227 offset:12288
    ds_read_b64 a[86:87], v204 offset:352
    v_mfma_f32_16x16x32_bf16 v[140:143], a[196:199], v[76:79], v[140:143]
    ds_read_b64_tr_b16 v[62:63], v227 offset:12800
    s_waitcnt lgkmcnt(15)
    v_mfma_f32_16x16x32_bf16 v[112:115], a[136:139], v[156:159], v[112:115]
    ds_read_b64_tr_b16 v[64:65], v40 offset:16384
    ds_read_b64 a[88:89], v205 offset:384
    v_mfma_f32_16x16x32_bf16 v[116:119], a[200:203], v[156:159], v[116:119]
    ds_read_b64_tr_b16 v[66:67], v40 offset:16896
    ds_read_b64 a[90:91], v205 offset:416
    v_mfma_f32_16x16x32_bf16 v[120:123], a[136:139], v[160:163], v[120:123]
    ds_read_b64_tr_b16 v[68:69], v41 offset:16384
    ds_read_b64 a[92:93], v205 offset:448
    v_mfma_f32_16x16x32_bf16 v[124:127], a[200:203], v[160:163], v[124:127]
    ds_read_b64_tr_b16 v[70:71], v41 offset:16896
    s_waitcnt lgkmcnt(15)
    v_mfma_f32_16x16x32_bf16 v[128:131], a[136:139], v[164:167], v[128:131]
    ds_read_b64_tr_b16 v[72:73], v226 offset:16384
    ds_read_b64 a[94:95], v205 offset:480
    v_mfma_f32_16x16x32_bf16 v[132:135], a[200:203], v[164:167], v[132:135]
    ds_read_b64_tr_b16 v[74:75], v226 offset:16896
    v_mfma_f32_16x16x32_bf16 v[136:139], a[136:139], v[168:171], v[136:139]
    ds_read_b64_tr_b16 v[76:77], v227 offset:16384
    v_mfma_f32_16x16x32_bf16 v[140:143], a[200:203], v[168:171], v[140:143]
    ds_read_b64_tr_b16 v[78:79], v227 offset:16896
    s_waitcnt lgkmcnt(15)
    s_waitcnt vmcnt(4)
    v_mfma_f32_16x16x32_bf16 v[112:115], a[140:143], v[48:51], v[112:115]
    ds_read_b64_tr_b16 v[156:157], v40 offset:20480
    ds_read_b64 a[96:97], v204 offset:8320
    v_mfma_f32_16x16x32_bf16 v[116:119], a[204:207], v[48:51], v[116:119]
    ds_read_b64_tr_b16 v[158:159], v40 offset:20992
    ds_read_b64 a[98:99], v204 offset:8352
    v_mfma_f32_16x16x32_bf16 v[120:123], a[140:143], v[52:55], v[120:123]
    ds_read_b64_tr_b16 v[160:161], v41 offset:20480
    ds_read_b64 a[100:101], v204 offset:8384
    v_mfma_f32_16x16x32_bf16 v[124:127], a[204:207], v[52:55], v[124:127]
    ds_read_b64_tr_b16 v[162:163], v41 offset:20992
    s_waitcnt lgkmcnt(15)
    v_mfma_f32_16x16x32_bf16 v[128:131], a[140:143], v[56:59], v[128:131]
    ds_read_b64_tr_b16 v[164:165], v226 offset:20480
    ds_read_b64 a[102:103], v204 offset:8416
    v_mfma_f32_16x16x32_bf16 v[132:135], a[204:207], v[56:59], v[132:135]
    ds_read_b64_tr_b16 v[166:167], v226 offset:20992
    ds_read_b64 a[104:105], v205 offset:8448
    v_mfma_f32_16x16x32_bf16 v[136:139], a[140:143], v[60:63], v[136:139]
    ds_read_b64_tr_b16 v[168:169], v227 offset:20480
    ds_read_b64 a[106:107], v205 offset:8480
    v_mfma_f32_16x16x32_bf16 v[140:143], a[204:207], v[60:63], v[140:143]
    ds_read_b64_tr_b16 v[170:171], v227 offset:20992
    s_waitcnt lgkmcnt(15)
    v_mfma_f32_16x16x32_bf16 v[112:115], a[144:147], v[64:67], v[112:115]
    ds_read_b64_tr_b16 v[48:49], v40 offset:24576
    ds_read_b64 a[108:109], v205 offset:8512
    s_add_u32 m0, s90, 73728
    v_mfma_f32_16x16x32_bf16 v[116:119], a[208:211], v[64:67], v[116:119]
    ds_read_b64_tr_b16 v[50:51], v40 offset:25088
    ds_read_b64 a[110:111], v205 offset:8544
    v_add_u32 v228, 131072, v207
    v_mfma_f32_16x16x32_bf16 v[120:123], a[144:147], v[68:71], v[120:123]
    ds_read_b64_tr_b16 v[52:53], v41 offset:24576
    ds_read_b64 a[112:113], v204 offset:8576
    buffer_load_dwordx4 v228, s[20:23], s32 offen lds
    v_mfma_f32_16x16x32_bf16 v[124:127], a[208:211], v[68:71], v[124:127]
    ds_read_b64_tr_b16 v[54:55], v41 offset:25088
    s_waitcnt lgkmcnt(15)
    v_mfma_f32_16x16x32_bf16 v[128:131], a[144:147], v[72:75], v[128:131]
    ds_read_b64_tr_b16 v[56:57], v226 offset:24576
    ds_read_b64 a[114:115], v204 offset:8608
    v_mfma_f32_16x16x32_bf16 v[132:135], a[208:211], v[72:75], v[132:135]
    ds_read_b64_tr_b16 v[58:59], v226 offset:25088
    ds_read_b64 a[116:117], v204 offset:8640
    s_add_u32 m0, m0, 1040
    v_mfma_f32_16x16x32_bf16 v[136:139], a[144:147], v[76:79], v[136:139]
    ds_read_b64_tr_b16 v[60:61], v227 offset:24576
    ds_read_b64 a[118:119], v204 offset:8672
    v_mfma_f32_16x16x32_bf16 v[140:143], a[208:211], v[76:79], v[140:143]
    ds_read_b64_tr_b16 v[62:63], v227 offset:25088
    s_waitcnt lgkmcnt(15)
    buffer_load_dwordx4 v228, s[20:23], s33 offen lds
    v_mfma_f32_16x16x32_bf16 v[112:115], a[148:151], v[156:159], v[112:115]
    ds_read_b64_tr_b16 v[64:65], v40 offset:28672
    ds_read_b64 a[120:121], v205 offset:8704
    v_mfma_f32_16x16x32_bf16 v[116:119], a[212:215], v[156:159], v[116:119]
    ds_read_b64_tr_b16 v[66:67], v40 offset:29184
    ds_read_b64 a[122:123], v205 offset:8736
    v_mfma_f32_16x16x32_bf16 v[120:123], a[148:151], v[160:163], v[120:123]
    ds_read_b64_tr_b16 v[68:69], v41 offset:28672
    ds_read_b64 a[124:125], v205 offset:8768
    s_add_u32 m0, m0, 1040
    v_mfma_f32_16x16x32_bf16 v[124:127], a[212:215], v[160:163], v[124:127]
    ds_read_b64_tr_b16 v[70:71], v41 offset:29184
    s_waitcnt lgkmcnt(15)
    v_mfma_f32_16x16x32_bf16 v[128:131], a[148:151], v[164:167], v[128:131]
    ds_read_b64_tr_b16 v[72:73], v226 offset:28672
    ds_read_b64 a[126:127], v205 offset:8800
    buffer_load_dwordx4 v228, s[20:23], s34 offen lds
    v_mfma_f32_16x16x32_bf16 v[132:135], a[212:215], v[164:167], v[132:135]
    ds_read_b64_tr_b16 v[74:75], v226 offset:29184
    v_mfma_f32_16x16x32_bf16 v[136:139], a[148:151], v[168:171], v[136:139]
    ds_read_b64_tr_b16 v[76:77], v227 offset:28672
    v_mfma_f32_16x16x32_bf16 v[140:143], a[212:215], v[168:171], v[140:143]
    ds_read_b64_tr_b16 v[78:79], v227 offset:29184
    s_waitcnt lgkmcnt(15)
    s_add_u32 m0, m0, 1040
    s_waitcnt vmcnt(3)
    s_barrier
    s_cmp_eq_u32 s50, 0
    s_cbranch_scc0 sig_30
    s_mov_b64 exec, 0xf
    buffer_atomic_add v7, v6, s[4:7], s68 offen sc1
    s_mov_b64 exec, -1
sig_30:
    v_mfma_f32_16x16x32_bf16 v[112:115], a[152:155], v[48:51], v[112:115]
    ds_read_b64_tr_b16 v[156:157], v40 offset:32768
    v_mfma_f32_16x16x32_bf16 v[116:119], a[216:219], v[48:51], v[116:119]
    ds_read_b64_tr_b16 v[158:159], v40 offset:33280
    buffer_load_dwordx4 v228, s[20:23], s35 offen lds
    v_mfma_f32_16x16x32_bf16 v[120:123], a[152:155], v[52:55], v[120:123]
    ds_read_b64_tr_b16 v[160:161], v41 offset:32768
    v_mfma_f32_16x16x32_bf16 v[124:127], a[216:219], v[52:55], v[124:127]
    ds_read_b64_tr_b16 v[162:163], v41 offset:33280
    s_waitcnt lgkmcnt(15)
    v_mfma_f32_16x16x32_bf16 v[128:131], a[152:155], v[56:59], v[128:131]
    ds_read_b64_tr_b16 v[164:165], v226 offset:32768
    s_add_u32 m0, m0, 1040
    v_mfma_f32_16x16x32_bf16 v[132:135], a[216:219], v[56:59], v[132:135]
    ds_read_b64_tr_b16 v[166:167], v226 offset:33280
    v_mfma_f32_16x16x32_bf16 v[136:139], a[152:155], v[60:63], v[136:139]
    ds_read_b64_tr_b16 v[168:169], v227 offset:32768
    buffer_load_dwordx4 v228, s[20:23], s36 offen lds
    v_mfma_f32_16x16x32_bf16 v[140:143], a[216:219], v[60:63], v[140:143]
    ds_read_b64_tr_b16 v[170:171], v227 offset:33280
    s_waitcnt lgkmcnt(13)
    v_mfma_f32_16x16x32_bf16 v[112:115], a[156:159], v[64:67], v[112:115]
    ds_read_b64_tr_b16 v[48:49], v40 offset:36864
    v_mfma_f32_16x16x32_bf16 v[116:119], a[220:223], v[64:67], v[116:119]
    ds_read_b64_tr_b16 v[50:51], v40 offset:37376
    s_add_u32 m0, m0, 1040
    v_mfma_f32_16x16x32_bf16 v[120:123], a[156:159], v[68:71], v[120:123]
    ds_read_b64_tr_b16 v[52:53], v41 offset:36864
    v_mfma_f32_16x16x32_bf16 v[124:127], a[220:223], v[68:71], v[124:127]
    ds_read_b64_tr_b16 v[54:55], v41 offset:37376
    s_waitcnt lgkmcnt(12)
    buffer_load_dwordx4 v228, s[20:23], s37 offen lds
    v_mfma_f32_16x16x32_bf16 v[128:131], a[156:159], v[72:75], v[128:131]
    ds_read_b64_tr_b16 v[56:57], v226 offset:36864
    v_mfma_f32_16x16x32_bf16 v[132:135], a[220:223], v[72:75], v[132:135]
    ds_read_b64_tr_b16 v[58:59], v226 offset:37376
    v_mfma_f32_16x16x32_bf16 v[136:139], a[156:159], v[76:79], v[136:139]
    ds_read_b64_tr_b16 v[60:61], v227 offset:36864
    s_add_u32 m0, m0, 1040
    v_mfma_f32_16x16x32_bf16 v[140:143], a[220:223], v[76:79], v[140:143]
    ds_read_b64_tr_b16 v[62:63], v227 offset:37376
    s_waitcnt lgkmcnt(12)
    v_mfma_f32_16x16x32_bf16 v[112:115], a[160:163], v[156:159], v[112:115]
    ds_read_b64_tr_b16 v[64:65], v40 offset:40960
    buffer_load_dwordx4 v228, s[20:23], s38 offen lds
    v_mfma_f32_16x16x32_bf16 v[116:119], a[224:227], v[156:159], v[116:119]
    ds_read_b64_tr_b16 v[66:67], v40 offset:41472
    v_mfma_f32_16x16x32_bf16 v[120:123], a[160:163], v[160:163], v[120:123]
    ds_read_b64_tr_b16 v[68:69], v41 offset:40960
    v_mfma_f32_16x16x32_bf16 v[124:127], a[224:227], v[160:163], v[124:127]
    ds_read_b64_tr_b16 v[70:71], v41 offset:41472
    s_waitcnt lgkmcnt(12)
    s_add_u32 m0, m0, 1040
    v_mfma_f32_16x16x32_bf16 v[128:131], a[160:163], v[164:167], v[128:131]
    ds_read_b64_tr_b16 v[72:73], v226 offset:40960
    v_mfma_f32_16x16x32_bf16 v[132:135], a[224:227], v[164:167], v[132:135]
    ds_read_b64_tr_b16 v[74:75], v226 offset:41472
    buffer_load_dwordx4 v228, s[20:23], s39 offen lds
    v_mfma_f32_16x16x32_bf16 v[136:139], a[160:163], v[168:171], v[136:139]
    ds_read_b64_tr_b16 v[76:77], v227 offset:40960
    v_mfma_f32_16x16x32_bf16 v[140:143], a[224:227], v[168:171], v[140:143]
    ds_read_b64_tr_b16 v[78:79], v227 offset:41472
    s_waitcnt lgkmcnt(12)
    s_barrier
    v_mfma_f32_16x16x32_bf16 v[112:115], a[164:167], v[48:51], v[112:115]
    ds_read_b64_tr_b16 v[156:157], v40 offset:45056
    s_add_u32 m0, s90, 82048
    v_add_u32 v228, 196608, v207
    v_mfma_f32_16x16x32_bf16 v[116:119], a[228:231], v[48:51], v[116:119]
    ds_read_b64_tr_b16 v[158:159], v40 offset:45568
    v_mfma_f32_16x16x32_bf16 v[120:123], a[164:167], v[52:55], v[120:123]
    ds_read_b64_tr_b16 v[160:161], v41 offset:45056
    buffer_load_dwordx4 v228, s[20:23], s32 offen lds
    v_mfma_f32_16x16x32_bf16 v[124:127], a[228:231], v[52:55], v[124:127]
    ds_read_b64_tr_b16 v[162:163], v41 offset:45568
    s_waitcnt lgkmcnt(12)
    v_mfma_f32_16x16x32_bf16 v[128:131], a[164:167], v[56:59], v[128:131]
    ds_read_b64_tr_b16 v[164:165], v226 offset:45056
    v_mfma_f32_16x16x32_bf16 v[132:135], a[228:231], v[56:59], v[132:135]
    ds_read_b64_tr_b16 v[166:167], v226 offset:45568
    s_add_u32 m0, m0, 1040
    v_mfma_f32_16x16x32_bf16 v[136:139], a[164:167], v[60:63], v[136:139]
    ds_read_b64_tr_b16 v[168:169], v227 offset:45056
    v_mfma_f32_16x16x32_bf16 v[140:143], a[228:231], v[60:63], v[140:143]
    ds_read_b64_tr_b16 v[170:171], v227 offset:45568
    s_waitcnt lgkmcnt(12)
    buffer_load_dwordx4 v228, s[20:23], s33 offen lds
    v_mfma_f32_16x16x32_bf16 v[112:115], a[168:171], v[64:67], v[112:115]
    ds_read_b64_tr_b16 v[48:49], v40 offset:49152
    v_mfma_f32_16x16x32_bf16 v[116:119], a[232:235], v[64:67], v[116:119]
    ds_read_b64_tr_b16 v[50:51], v40 offset:49664
    v_mfma_f32_16x16x32_bf16 v[120:123], a[168:171], v[68:71], v[120:123]
    ds_read_b64_tr_b16 v[52:53], v41 offset:49152
    s_add_u32 m0, m0, 1040
    v_mfma_f32_16x16x32_bf16 v[124:127], a[232:235], v[68:71], v[124:127]
    ds_read_b64_tr_b16 v[54:55], v41 offset:49664
    s_waitcnt lgkmcnt(12)
    v_mfma_f32_16x16x32_bf16 v[128:131], a[168:171], v[72:75], v[128:131]
    ds_read_b64_tr_b16 v[56:57], v226 offset:49152
    buffer_load_dwordx4 v228, s[20:23], s34 offen lds
    v_mfma_f32_16x16x32_bf16 v[132:135], a[232:235], v[72:75], v[132:135]
    ds_read_b64_tr_b16 v[58:59], v226 offset:49664
    v_mfma_f32_16x16x32_bf16 v[136:139], a[168:171], v[76:79], v[136:139]
    ds_read_b64_tr_b16 v[60:61], v227 offset:49152
    v_mfma_f32_16x16x32_bf16 v[140:143], a[232:235], v[76:79], v[140:143]
    ds_read_b64_tr_b16 v[62:63], v227 offset:49664
    s_waitcnt lgkmcnt(12)
    s_add_u32 m0, m0, 1040
    v_mfma_f32_16x16x32_bf16 v[112:115], a[172:175], v[156:159], v[112:115]
    ds_read_b64_tr_b16 v[64:65], v40 offset:53248
    v_mfma_f32_16x16x32_bf16 v[116:119], a[236:239], v[156:159], v[116:119]
    ds_read_b64_tr_b16 v[66:67], v40 offset:53760
    buffer_load_dwordx4 v228, s[20:23], s35 offen lds
    v_mfma_f32_16x16x32_bf16 v[120:123], a[172:175], v[160:163], v[120:123]
    ds_read_b64_tr_b16 v[68:69], v41 offset:53248
    v_mfma_f32_16x16x32_bf16 v[124:127], a[236:239], v[160:163], v[124:127]
    ds_read_b64_tr_b16 v[70:71], v41 offset:53760
    s_waitcnt lgkmcnt(12)
    v_mfma_f32_16x16x32_bf16 v[128:131], a[172:175], v[164:167], v[128:131]
    ds_read_b64_tr_b16 v[72:73], v226 offset:53248
    s_add_u32 m0, m0, 1040
    v_mfma_f32_16x16x32_bf16 v[132:135], a[236:239], v[164:167], v[132:135]
    ds_read_b64_tr_b16 v[74:75], v226 offset:53760
    v_mfma_f32_16x16x32_bf16 v[136:139], a[172:175], v[168:171], v[136:139]
    ds_read_b64_tr_b16 v[76:77], v227 offset:53248
    buffer_load_dwordx4 v228, s[20:23], s36 offen lds
    v_mfma_f32_16x16x32_bf16 v[140:143], a[236:239], v[168:171], v[140:143]
    ds_read_b64_tr_b16 v[78:79], v227 offset:53760
    s_waitcnt lgkmcnt(12)
    v_mfma_f32_16x16x32_bf16 v[112:115], a[176:179], v[48:51], v[112:115]
    ds_read_b64_tr_b16 v[156:157], v40 offset:57344
    v_mfma_f32_16x16x32_bf16 v[116:119], a[240:243], v[48:51], v[116:119]
    ds_read_b64_tr_b16 v[158:159], v40 offset:57856
    s_add_u32 m0, m0, 1040
    v_mfma_f32_16x16x32_bf16 v[120:123], a[176:179], v[52:55], v[120:123]
    ds_read_b64_tr_b16 v[160:161], v41 offset:57344
    v_mfma_f32_16x16x32_bf16 v[124:127], a[240:243], v[52:55], v[124:127]
    ds_read_b64_tr_b16 v[162:163], v41 offset:57856
    s_waitcnt lgkmcnt(12)
    buffer_load_dwordx4 v228, s[20:23], s37 offen lds
    v_mfma_f32_16x16x32_bf16 v[128:131], a[176:179], v[56:59], v[128:131]
    ds_read_b64_tr_b16 v[164:165], v226 offset:57344
    v_mfma_f32_16x16x32_bf16 v[132:135], a[240:243], v[56:59], v[132:135]
    ds_read_b64_tr_b16 v[166:167], v226 offset:57856
    v_mfma_f32_16x16x32_bf16 v[136:139], a[176:179], v[60:63], v[136:139]
    ds_read_b64_tr_b16 v[168:169], v227 offset:57344
    s_add_u32 m0, m0, 1040
    v_mfma_f32_16x16x32_bf16 v[140:143], a[240:243], v[60:63], v[140:143]
    ds_read_b64_tr_b16 v[170:171], v227 offset:57856
    s_waitcnt lgkmcnt(12)
    v_mfma_f32_16x16x32_bf16 v[112:115], a[180:183], v[64:67], v[112:115]
    ds_read_b64_tr_b16 v[48:49], v40 offset:61440
    buffer_load_dwordx4 v228, s[20:23], s38 offen lds
    v_mfma_f32_16x16x32_bf16 v[116:119], a[244:247], v[64:67], v[116:119]
    ds_read_b64_tr_b16 v[50:51], v40 offset:61952
    v_mfma_f32_16x16x32_bf16 v[120:123], a[180:183], v[68:71], v[120:123]
    ds_read_b64_tr_b16 v[52:53], v41 offset:61440
    v_mfma_f32_16x16x32_bf16 v[124:127], a[244:247], v[68:71], v[124:127]
    ds_read_b64_tr_b16 v[54:55], v41 offset:61952
    s_waitcnt lgkmcnt(12)
    s_add_u32 m0, m0, 1040
    v_mfma_f32_16x16x32_bf16 v[128:131], a[180:183], v[72:75], v[128:131]
    ds_read_b64_tr_b16 v[56:57], v226 offset:61440
    v_mfma_f32_16x16x32_bf16 v[132:135], a[244:247], v[72:75], v[132:135]
    ds_read_b64_tr_b16 v[58:59], v226 offset:61952
    buffer_load_dwordx4 v228, s[20:23], s39 offen lds
    v_mfma_f32_16x16x32_bf16 v[136:139], a[180:183], v[76:79], v[136:139]
    ds_read_b64_tr_b16 v[60:61], v227 offset:61440
    v_mfma_f32_16x16x32_bf16 v[140:143], a[244:247], v[76:79], v[140:143]
    ds_read_b64_tr_b16 v[62:63], v227 offset:61952
    s_waitcnt lgkmcnt(12)
    v_mfma_f32_16x16x32_bf16 v[112:115], a[184:187], v[156:159], v[112:115]
    s_add_u32 m0, s59, 0
    v_add_u32 v228, 131584, v207
    v_mfma_f32_16x16x32_bf16 v[116:119], a[248:251], v[156:159], v[116:119]
    v_mfma_f32_16x16x32_bf16 v[120:123], a[184:187], v[160:163], v[120:123]
    buffer_load_dwordx4 v228, s[20:23], s32 offen lds
    v_mfma_f32_16x16x32_bf16 v[124:127], a[248:251], v[160:163], v[124:127]
    s_waitcnt lgkmcnt(8)
    v_mfma_f32_16x16x32_bf16 v[128:131], a[184:187], v[164:167], v[128:131]
    v_mfma_f32_16x16x32_bf16 v[132:135], a[248:251], v[164:167], v[132:135]
    s_add_u32 m0, m0, 1040
    v_mfma_f32_16x16x32_bf16 v[136:139], a[184:187], v[168:171], v[136:139]
    v_mfma_f32_16x16x32_bf16 v[140:143], a[248:251], v[168:171], v[140:143]
    s_waitcnt lgkmcnt(4)
    buffer_load_dwordx4 v228, s[20:23], s33 offen lds
    v_mfma_f32_16x16x32_bf16 v[112:115], a[188:191], v[48:51], v[112:115]
    v_mfma_f32_16x16x32_bf16 v[116:119], a[252:255], v[48:51], v[116:119]
    v_mfma_f32_16x16x32_bf16 v[120:123], a[188:191], v[52:55], v[120:123]
    s_add_u32 m0, m0, 1040
    v_mfma_f32_16x16x32_bf16 v[124:127], a[252:255], v[52:55], v[124:127]
    s_waitcnt lgkmcnt(0)
    v_mfma_f32_16x16x32_bf16 v[128:131], a[188:191], v[56:59], v[128:131]
    buffer_load_dwordx4 v228, s[20:23], s34 offen lds
    v_mfma_f32_16x16x32_bf16 v[132:135], a[252:255], v[56:59], v[132:135]
    v_mfma_f32_16x16x32_bf16 v[136:139], a[188:191], v[60:63], v[136:139]
    v_mfma_f32_16x16x32_bf16 v[140:143], a[252:255], v[60:63], v[140:143]
    s_add_u32 m0, m0, 1040
    s_barrier
    s_mov_b32 s55, s100
    s_mov_b32 s56, s101
    s_cmp_eq_u32 s52, 3
    s_cselect_b32 s96, s96, s26
    buffer_load_dwordx4 v228, s[20:23], s35 offen lds
    s_add_u32 m0, m0, 1040
    s_waitcnt vmcnt(12)
    ds_read_b64 a[128:129], v204 offset:0
    ds_read_b64 a[130:131], v204 offset:32
    ds_read_b64 a[132:133], v204 offset:64
    ds_read_b64 a[134:135], v204 offset:96
    ds_read_b64 a[136:137], v205 offset:128
    ds_read_b64 a[138:139], v205 offset:160
    ds_read_b64 a[140:141], v205 offset:192
    ds_read_b64 a[142:143], v205 offset:224
    ds_read_b64 a[144:145], v204 offset:256
    ds_read_b64 a[146:147], v204 offset:288
    buffer_load_dwordx4 v228, s[20:23], s36 offen lds
    s_add_u32 m0, m0, 1040
    ds_read_b64 a[148:149], v204 offset:320
    ds_read_b64 a[150:151], v204 offset:352
    ds_read_b64 a[152:153], v205 offset:384
    ds_read_b64 a[154:155], v205 offset:416
    ds_read_b64 a[156:157], v205 offset:448
    ds_read_b64 a[158:159], v205 offset:480
    s_nop 0
    v_pk_fma_f32 v[196:197], v[24:25], v[192:193], v[28:29] op_sel:[0,0,0] op_sel_hi:[1,0,1]
    v_pk_fma_f32 v[198:199], v[26:27], v[192:193], v[30:31] op_sel:[0,0,0] op_sel_hi:[1,0,1]
    v_pk_fma_f32 v[200:201], v[32:33], v[192:193], v[36:37] op_sel:[0,0,0] op_sel_hi:[1,0,1]
    v_pk_fma_f32 v[202:203], v[34:35], v[192:193], v[38:39] op_sel:[0,0,0] op_sel_hi:[1,0,1]
    buffer_load_dwordx4 v228, s[20:23], s37 offen lds
    s_add_u32 m0, m0, 1040
    v_pk_fma_f32 v[112:113], v[112:113], v[188:189], v[196:197] op_sel:[0,0,0] op_sel_hi:[1,0,1]
    v_pk_fma_f32 v[114:115], v[114:115], v[188:189], v[198:199] op_sel:[0,0,0] op_sel_hi:[1,0,1]
    v_pk_fma_f32 v[116:117], v[116:117], v[188:189], v[200:201] op_sel:[0,0,0] op_sel_hi:[1,0,1]
    v_pk_fma_f32 v[118:119], v[118:119], v[188:189], v[202:203] op_sel:[0,0,0] op_sel_hi:[1,0,1]
    v_pk_fma_f32 v[196:197], v[24:25], v[192:193], v[28:29] op_sel:[0,1,0] op_sel_hi:[1,1,1]
    v_pk_fma_f32 v[198:199], v[26:27], v[192:193], v[30:31] op_sel:[0,1,0] op_sel_hi:[1,1,1]
    v_pk_fma_f32 v[200:201], v[32:33], v[192:193], v[36:37] op_sel:[0,1,0] op_sel_hi:[1,1,1]
    v_pk_fma_f32 v[202:203], v[34:35], v[192:193], v[38:39] op_sel:[0,1,0] op_sel_hi:[1,1,1]
    v_pk_fma_f32 v[120:121], v[120:121], v[188:189], v[196:197] op_sel:[0,1,0] op_sel_hi:[1,1,1]
    v_pk_fma_f32 v[122:123], v[122:123], v[188:189], v[198:199] op_sel:[0,1,0] op_sel_hi:[1,1,1]
    buffer_load_dwordx4 v228, s[20:23], s38 offen lds
    s_add_u32 m0, m0, 1040
    v_pk_fma_f32 v[124:125], v[124:125], v[188:189], v[200:201] op_sel:[0,1,0] op_sel_hi:[1,1,1]
    v_pk_fma_f32 v[126:127], v[126:127], v[188:189], v[202:203] op_sel:[0,1,0] op_sel_hi:[1,1,1]
    v_pk_fma_f32 v[196:197], v[24:25], v[194:195], v[28:29] op_sel:[0,0,0] op_sel_hi:[1,0,1]
    v_pk_fma_f32 v[198:199], v[26:27], v[194:195], v[30:31] op_sel:[0,0,0] op_sel_hi:[1,0,1]
    v_pk_fma_f32 v[200:201], v[32:33], v[194:195], v[36:37] op_sel:[0,0,0] op_sel_hi:[1,0,1]
    v_pk_fma_f32 v[202:203], v[34:35], v[194:195], v[38:39] op_sel:[0,0,0] op_sel_hi:[1,0,1]
    v_pk_fma_f32 v[128:129], v[128:129], v[190:191], v[196:197] op_sel:[0,0,0] op_sel_hi:[1,0,1]
    v_pk_fma_f32 v[130:131], v[130:131], v[190:191], v[198:199] op_sel:[0,0,0] op_sel_hi:[1,0,1]
    v_pk_fma_f32 v[132:133], v[132:133], v[190:191], v[200:201] op_sel:[0,0,0] op_sel_hi:[1,0,1]
    v_pk_fma_f32 v[134:135], v[134:135], v[190:191], v[202:203] op_sel:[0,0,0] op_sel_hi:[1,0,1]
    buffer_load_dwordx4 v228, s[20:23], s39 offen lds
    v_pk_fma_f32 v[196:197], v[24:25], v[194:195], v[28:29] op_sel:[0,1,0] op_sel_hi:[1,1,1]
    v_pk_fma_f32 v[198:199], v[26:27], v[194:195], v[30:31] op_sel:[0,1,0] op_sel_hi:[1,1,1]
    v_pk_fma_f32 v[200:201], v[32:33], v[194:195], v[36:37] op_sel:[0,1,0] op_sel_hi:[1,1,1]
    v_pk_fma_f32 v[202:203], v[34:35], v[194:195], v[38:39] op_sel:[0,1,0] op_sel_hi:[1,1,1]
    v_pk_fma_f32 v[136:137], v[136:137], v[190:191], v[196:197] op_sel:[0,1,0] op_sel_hi:[1,1,1]
    v_pk_fma_f32 v[138:139], v[138:139], v[190:191], v[198:199] op_sel:[0,1,0] op_sel_hi:[1,1,1]
    v_pk_fma_f32 v[140:141], v[140:141], v[190:191], v[200:201] op_sel:[0,1,0] op_sel_hi:[1,1,1]
    v_pk_fma_f32 v[142:143], v[142:143], v[190:191], v[202:203] op_sel:[0,1,0] op_sel_hi:[1,1,1]
    s_waitcnt vmcnt(8)
    ds_read_b64 a[192:193], v204 offset:8320
    ds_read_b64 a[194:195], v204 offset:8352
    s_add_u32 m0, s59, 33280
    v_add_u32 v228, 197120, v207
    buffer_load_dwordx4 v228, s[20:23], s32 offen lds
    s_add_u32 m0, m0, 1040
    ds_read_b64 a[196:197], v204 offset:8384
    ds_read_b64 a[198:199], v204 offset:8416
    ds_read_b64 a[200:201], v205 offset:8448
    ds_read_b64 a[202:203], v205 offset:8480
    ds_read_b64 a[204:205], v205 offset:8512
    ds_read_b64 a[206:207], v205 offset:8544
    ds_read_b64 a[208:209], v204 offset:8576
    ds_read_b64 a[210:211], v204 offset:8608
    ds_read_b64 a[212:213], v204 offset:8640
    ds_read_b64 a[214:215], v204 offset:8672
    buffer_load_dwordx4 v228, s[20:23], s33 offen lds
    s_add_u32 m0, m0, 1040
    ds_read_b64 a[216:217], v205 offset:8704
    ds_read_b64 a[218:219], v205 offset:8736
    ds_read_b64 a[220:221], v205 offset:8768
    ds_read_b64 a[222:223], v205 offset:8800
    v_mov_b32 v4, v47
    v_mov_b32 v6, s80
    buffer_load_dwordx4 v228, s[20:23], s34 offen lds
    s_add_u32 m0, m0, 1040
    s_nop 0
    buffer_load_dwordx4 v228, s[20:23], s35 offen lds
    s_add_u32 m0, m0, 1040
    s_mov_b64 exec, 1
    buffer_load_dword v7, v6, s[4:7], 0 offen sc1
    s_mov_b64 exec, -1
    buffer_load_dwordx4 v228, s[20:23], s36 offen lds
    s_add_u32 m0, m0, 1040
    s_nop 0
    buffer_load_dwordx4 v228, s[20:23], s37 offen lds
    s_add_u32 m0, m0, 1040
    s_nop 0
    buffer_load_dwordx4 v228, s[20:23], s38 offen lds
    s_add_u32 m0, m0, 1040
    s_nop 0
    buffer_load_dwordx4 v228, s[20:23], s39 offen lds
    s_mov_b64 exec, 0x1
    s_mov_b32 s54, 0
    s_waitcnt vmcnt(4)
    s_branch poll_31c
poll_31:
    buffer_load_dword v7, v6, s[4:7], 0 offen sc1
    s_waitcnt vmcnt(0)
poll_31c:
    v_cmp_gt_u32 vcc, 8, v7
    s_add_u32 s54, s54, 1
    s_cbranch_vccz pollx_32
    s_sleep 4
    s_cmp_lt_u32 s54, 0x40000
    s_cbranch_scc1 poll_31
pollx_32:
    s_mov_b64 exec, -1
    s_add_u32 s64, s8, 0
    buffer_load_dwordx4 v[16:19], v4, s[4:7], s64 offen offset:0 sc1
    buffer_load_dwordx4 v[20:23], v4, s[4:7], s64 offen offset:1024 sc1
    buffer_load_dwordx4 v[24:27], v4, s[4:7], s64 offen offset:2048 sc1
    buffer_load_dwordx4 v[28:31], v4, s[4:7], s64 offen offset:3072 sc1
    s_add_u32 s64, s8, 4096
    buffer_load_dwordx4 v[32:35], v4, s[4:7], s64 offen offset:0 sc1
    buffer_load_dwordx4 v[36:39], v4, s[4:7], s64 offen offset:1024 sc1
    buffer_load_dwordx4 v[40:43], v4, s[4:7], s64 offen offset:2048 sc1
    buffer_load_dwordx4 v[44:47], v4, s[4:7], s64 offen offset:3072 sc1
    s_add_u32 s64, s8, 8192
    buffer_load_dwordx4 v[48:51], v4, s[4:7], s64 offen offset:0 sc1
    buffer_load_dwordx4 v[52:55], v4, s[4:7], s64 offen offset:1024 sc1
    s_waitcnt vmcnt(10)
    s_waitcnt lgkmcnt(0)
    s_waitcnt vmcnt(9)
    v_mfma_f32_16x16x32_bf16 v[80:83], v[16:19], a[0:3], 0
    buffer_load_dwordx4 v[56:59], v4, s[4:7], s64 offen offset:2048 sc1
    buffer_load_dwordx4 v[60:63], v4, s[4:7], s64 offen offset:3072 sc1
    v_mfma_f32_16x16x32_bf16 v[84:87], v[16:19], a[64:67], 0
    ds_read_b64 a[160:161], v208 offset:0
    ds_read_b64 a[162:163], v208 offset:32
    v_mfma_f32_16x16x32_bf16 v[88:91], v[16:19], a[128:131], 0
    ds_read_b64 a[164:165], v208 offset:64
    ds_read_b64 a[166:167], v208 offset:96
    v_mfma_f32_16x16x32_bf16 v[92:95], v[16:19], a[192:195], 0
    ds_read_b64 a[168:169], v209 offset:128
    s_waitcnt vmcnt(10)
    v_mfma_f32_16x16x32_bf16 v[80:83], v[20:23], a[4:7], v[80:83]
    s_add_u32 s64, s8, 12288
    buffer_load_dwordx4 v[64:67], v4, s[4:7], s64 offen offset:0 sc1
    v_mfma_f32_16x16x32_bf16 v[84:87], v[20:23], a[68:71], v[84:87]
    buffer_load_dwordx4 v[68:71], v4, s[4:7], s64 offen offset:1024 sc1
    ds_read_b64 a[170:171], v209 offset:160
    v_mfma_f32_16x16x32_bf16 v[88:91], v[20:23], a[132:135], v[88:91]
    ds_read_b64 a[172:173], v209 offset:192
    ds_read_b64 a[174:175], v209 offset:224
    v_mfma_f32_16x16x32_bf16 v[92:95], v[20:23], a[196:199], v[92:95]
    ds_read_b64 a[176:177], v208 offset:256
    s_waitcnt vmcnt(11)
    v_mfma_f32_16x16x32_bf16 v[80:83], v[24:27], a[8:11], v[80:83]
    buffer_load_dwordx4 v[16:19], v4, s[4:7], s64 offen offset:2048 sc1
    ds_read_b64 a[178:179], v208 offset:288
    v_mfma_f32_16x16x32_bf16 v[84:87], v[24:27], a[72:75], v[84:87]
    ds_read_b64 a[180:181], v208 offset:320
    ds_read_b64 a[182:183], v208 offset:352
    v_mfma_f32_16x16x32_bf16 v[88:91], v[24:27], a[136:139], v[88:91]
    ds_read_b64 a[184:185], v209 offset:384
    ds_read_b64 a[186:187], v209 offset:416
    v_mfma_f32_16x16x32_bf16 v[92:95], v[24:27], a[200:203], v[92:95]
    ds_read_b64 a[188:189], v209 offset:448
    s_waitcnt vmcnt(11)
    v_mfma_f32_16x16x32_bf16 v[80:83], v[28:31], a[12:15], v[80:83]
    buffer_load_dwordx4 v[20:23], v4, s[4:7], s64 offen offset:3072 sc1
    ds_read_b64 a[190:191], v209 offset:480
    v_mfma_f32_16x16x32_bf16 v[84:87], v[28:31], a[76:79], v[84:87]
    ds_read_b64 a[224:225], v208 offset:33280
    ds_read_b64 a[226:227], v208 offset:33312
    v_mfma_f32_16x16x32_bf16 v[88:91], v[28:31], a[140:143], v[88:91]
    ds_read_b64 a[228:229], v208 offset:33344
    ds_read_b64 a[230:231], v208 offset:33376
    v_mfma_f32_16x16x32_bf16 v[92:95], v[28:31], a[204:207], v[92:95]
    ds_read_b64 a[232:233], v209 offset:33408
    s_waitcnt vmcnt(11)
    v_mfma_f32_16x16x32_bf16 v[80:83], v[32:35], a[16:19], v[80:83]
    s_add_u32 s64, s9, 0
    buffer_load_dwordx4 v[24:27], v4, s[4:7], s64 offen offset:0 sc1
    v_mfma_f32_16x16x32_bf16 v[84:87], v[32:35], a[80:83], v[84:87]
    ds_read_b64 a[234:235], v209 offset:33440
    ds_read_b64 a[236:237], v209 offset:33472
    v_mfma_f32_16x16x32_bf16 v[88:91], v[32:35], a[144:147], v[88:91]
    ds_read_b64 a[238:239], v209 offset:33504
    ds_read_b64 a[240:241], v208 offset:33536
    v_mfma_f32_16x16x32_bf16 v[92:95], v[32:35], a[208:211], v[92:95]
    ds_read_b64 a[242:243], v208 offset:33568
    s_waitcnt vmcnt(11)
    v_mfma_f32_16x16x32_bf16 v[80:83], v[36:39], a[20:23], v[80:83]
    buffer_load_dwordx4 v[28:31], v4, s[4:7], s64 offen offset:1024 sc1
    ds_read_b64 a[244:245], v208 offset:33600
    v_mfma_f32_16x16x32_bf16 v[84:87], v[36:39], a[84:87], v[84:87]
    ds_read_b64 a[246:247], v208 offset:33632
    ds_read_b64 a[248:249], v209 offset:33664
    v_mfma_f32_16x16x32_bf16 v[88:91], v[36:39], a[148:151], v[88:91]
    ds_read_b64 a[250:251], v209 offset:33696
    ds_read_b64 a[252:253], v209 offset:33728
    v_mfma_f32_16x16x32_bf16 v[92:95], v[36:39], a[212:215], v[92:95]
    ds_read_b64 a[254:255], v209 offset:33760
    s_waitcnt vmcnt(11)
    v_mfma_f32_16x16x32_bf16 v[80:83], v[40:43], a[24:27], v[80:83]
    buffer_load_dwordx4 v[32:35], v4, s[4:7], s64 offen offset:2048 sc1
    v_mfma_f32_16x16x32_bf16 v[84:87], v[40:43], a[88:91], v[84:87]
    v_mfma_f32_16x16x32_bf16 v[88:91], v[40:43], a[152:155], v[88:91]
    v_mfma_f32_16x16x32_bf16 v[92:95], v[40:43], a[216:219], v[92:95]
    s_waitcnt vmcnt(11)
    v_mfma_f32_16x16x32_bf16 v[80:83], v[44:47], a[28:31], v[80:83]
    buffer_load_dwordx4 v[36:39], v4, s[4:7], s64 offen offset:3072 sc1
    v_mfma_f32_16x16x32_bf16 v[84:87], v[44:47], a[92:95], v[84:87]
    v_mfma_f32_16x16x32_bf16 v[88:91], v[44:47], a[156:159], v[88:91]
    v_mfma_f32_16x16x32_bf16 v[92:95], v[44:47], a[220:223], v[92:95]
    s_waitcnt vmcnt(11)
L_p4j:
    s_waitcnt lgkmcnt(0)
    s_barrier
    v_mfma_f32_16x16x32_bf16 v[80:83], v[48:51], a[32:35], v[80:83]
    s_add_u32 s64, s9, 4096
    buffer_load_dwordx4 v[40:43], v4, s[4:7], s64 offen offset:0 sc1
    v_mfma_f32_16x16x32_bf16 v[84:87], v[48:51], a[96:99], v[84:87]
    v_add_u32 v12, s15, v4
    v_lshrrev_b32 v5, 3, v1
    v_mfma_f32_16x16x32_bf16 v[88:91], v[48:51], a[160:163], v[88:91]
    v_and_b32 v13, 7, v1
    v_and_b32 v7, 6, v5
    v_mfma_f32_16x16x32_bf16 v[92:95], v[48:51], a[224:227], v[92:95]
    v_xor_b32 v13, v13, v7
    s_waitcnt vmcnt(11)
    v_mfma_f32_16x16x32_bf16 v[80:83], v[52:55], a[36:39], v[80:83]
    buffer_load_dwordx4 v[44:47], v4, s[4:7], s64 offen offset:1024 sc1
    v_lshlrev_b32 v13, 4, v13
    v_mfma_f32_16x16x32_bf16 v[84:87], v[52:55], a[100:103], v[84:87]
    v_lshl_add_u32 v13, v5, 10, v13
    v_lshlrev_b32 v14, 3, v1
    v_mfma_f32_16x16x32_bf16 v[88:91], v[52:55], a[164:167], v[88:91]
    v_lshlrev_b32 v15, 10, v1
    v_add_u32 v72, s18, v4
    v_mfma_f32_16x16x32_bf16 v[92:95], v[52:55], a[228:231], v[92:95]
    v_add_u32 v73, s19, v4
    s_waitcnt vmcnt(11)
    v_mfma_f32_16x16x32_bf16 v[80:83], v[56:59], a[40:43], v[80:83]
    buffer_load_dwordx4 v[48:51], v4, s[4:7], s64 offen offset:2048 sc1
    v_add_u32 v74, s40, v4
    v_mfma_f32_16x16x32_bf16 v[84:87], v[56:59], a[104:107], v[84:87]
    v_add_u32 v75, s41, v4
    v_add_u32 v76, s42, v4
    v_mfma_f32_16x16x32_bf16 v[88:91], v[56:59], a[168:171], v[88:91]
    v_add_u32_e64 v77, s43, v4
    v_mov_b32 v152, 0xc0135761
    v_mfma_f32_16x16x32_bf16 v[92:95], v[56:59], a[232:235], v[92:95]
    v_mul_f32 v144, v112, v112
    s_waitcnt vmcnt(11)
    v_mfma_f32_16x16x32_bf16 v[80:83], v[60:63], a[44:47], v[80:83]
    buffer_load_dwordx4 v[52:55], v4, s[4:7], s64 offen offset:3072 sc1
    v_mul_f32 v145, v113, v113
    v_mfma_f32_16x16x32_bf16 v[84:87], v[60:63], a[108:111], v[84:87]
    v_mul_f32 v146, v114, v114
    v_mul_f32_e64 v147, v115, v115
    v_mfma_f32_16x16x32_bf16 v[88:91], v[60:63], a[172:175], v[88:91]
    v_fma_f32 v144, v144, s58, v152
    v_fma_f32 v145, v145, s58, v152
    v_mfma_f32_16x16x32_bf16 v[92:95], v[60:63], a[236:239], v[92:95]
    v_fma_f32 v146, v146, s58, v152
    s_waitcnt vmcnt(11)
    v_mfma_f32_16x16x32_bf16 v[80:83], v[64:67], a[48:51], v[80:83]
    s_add_u32 s64, s9, 8192
    buffer_load_dwordx4 v[56:59], v4, s[4:7], s64 offen offset:0 sc1
    v_mfma_f32_16x16x32_bf16 v[84:87], v[64:67], a[112:115], v[84:87]
    v_fma_f32 v147, v147, s58, v152
    v_mul_f32 v144, v144, v112
    v_mfma_f32_16x16x32_bf16 v[88:91], v[64:67], a[176:179], v[88:91]
    v_mul_f32 v145, v145, v113
    v_mul_f32 v146, v146, v114
    v_mfma_f32_16x16x32_bf16 v[92:95], v[64:67], a[240:243], v[92:95]
    v_mul_f32 v147, v147, v115
    s_waitcnt vmcnt(11)
    v_mfma_f32_16x16x32_bf16 v[80:83], v[68:71], a[52:55], v[80:83]
    buffer_load_dwordx4 v[60:63], v4, s[4:7], s64 offen offset:1024 sc1
    v_mfma_f32_16x16x32_bf16 v[84:87], v[68:71], a[116:119], v[84:87]
    v_exp_f32 v144, v144
    v_mfma_f32_16x16x32_bf16 v[88:91], v[68:71], a[180:183], v[88:91]
    v_exp_f32 v145, v145
    v_mfma_f32_16x16x32_bf16 v[92:95], v[68:71], a[244:247], v[92:95]
    v_exp_f32 v146, v146
    s_waitcnt vmcnt(11)
    v_mfma_f32_16x16x32_bf16 v[80:83], v[16:19], a[56:59], v[80:83]
    buffer_load_dwordx4 v[64:67], v4, s[4:7], s64 offen offset:2048 sc1
    v_mfma_f32_16x16x32_bf16 v[84:87], v[16:19], a[120:123], v[84:87]
    v_exp_f32 v147, v147
    v_mfma_f32_16x16x32_bf16 v[88:91], v[16:19], a[184:187], v[88:91]
    v_add_f32 v144, 1.0, v144
    v_add_f32 v145, 1.0, v145
    v_mfma_f32_16x16x32_bf16 v[92:95], v[16:19], a[248:251], v[92:95]
    v_add_f32 v146, 1.0, v146
    s_waitcnt vmcnt(11)
    v_mfma_f32_16x16x32_bf16 v[80:83], v[20:23], a[60:63], v[80:83]
    buffer_load_dwordx4 v[68:71], v4, s[4:7], s64 offen offset:3072 sc1
    v_add_f32 v147, 1.0, v147
    v_mfma_f32_16x16x32_bf16 v[84:87], v[20:23], a[124:127], v[84:87]
    v_rcp_f32 v144, v144
    v_mfma_f32_16x16x32_bf16 v[88:91], v[20:23], a[188:191], v[88:91]
    v_rcp_f32 v145, v145
    v_mfma_f32_16x16x32_bf16 v[92:95], v[20:23], a[252:255], v[92:95]
    v_rcp_f32 v146, v146
    s_waitcnt vmcnt(11)
    v_mfma_f32_16x16x32_bf16 v[96:99], v[24:27], a[0:3], 0
    s_add_u32 s64, s9, 12288
    buffer_load_dwordx4 v[16:19], v4, s[4:7], s64 offen offset:0 sc1
    v_mfma_f32_16x16x32_bf16 v[100:103], v[24:27], a[64:67], 0
    v_rcp_f32 v147, v147
    v_mfma_f32_16x16x32_bf16 v[104:107], v[24:27], a[128:131], 0
    v_mul_f32 v112, v112, v144
    v_mul_f32 v113, v113, v145
    v_mfma_f32_16x16x32_bf16 v[108:111], v[24:27], a[192:195], 0
    v_mul_f32 v114, v114, v146
    s_waitcnt vmcnt(11)
    v_mfma_f32_16x16x32_bf16 v[96:99], v[28:31], a[4:7], v[96:99]
    buffer_load_dwordx4 v[20:23], v4, s[4:7], s64 offen offset:1024 sc1
    v_mul_f32 v115, v115, v147
    v_mfma_f32_16x16x32_bf16 v[100:103], v[28:31], a[68:71], v[100:103]
    v_mul_f32 v148, v116, v116
    v_mul_f32 v149, v117, v117
    v_mfma_f32_16x16x32_bf16 v[104:107], v[28:31], a[132:135], v[104:107]
    v_mul_f32 v150, v118, v118
    v_mul_f32 v151, v119, v119
    v_mfma_f32_16x16x32_bf16 v[108:111], v[28:31], a[196:199], v[108:111]
    v_fma_f32 v148, v148, s58, v152
    s_waitcnt vmcnt(11)
    v_mfma_f32_16x16x32_bf16 v[96:99], v[32:35], a[8:11], v[96:99]
    buffer_load_dwordx4 v[24:27], v4, s[4:7], s64 offen offset:2048 sc1
    v_fma_f32 v149, v149, s58, v152
    v_mfma_f32_16x16x32_bf16 v[100:103], v[32:35], a[72:75], v[100:103]
    v_fma_f32 v150, v150, s58, v152
    v_fma_f32 v151, v151, s58, v152
    v_mfma_f32_16x16x32_bf16 v[104:107], v[32:35], a[136:139], v[104:107]
    ds_write_b128 v12, v[80:83] offset:0
    v_mul_f32 v148, v148, v116
    v_mfma_f32_16x16x32_bf16 v[108:111], v[32:35], a[200:203], v[108:111]
    v_mul_f32 v149, v149, v117
    s_waitcnt vmcnt(11)
    v_mfma_f32_16x16x32_bf16 v[96:99], v[36:39], a[12:15], v[96:99]
    buffer_load_dwordx4 v[28:31], v4, s[4:7], s64 offen offset:3072 sc1
    v_mul_f32 v150, v150, v118
    v_mfma_f32_16x16x32_bf16 v[100:103], v[36:39], a[76:79], v[100:103]
    v_mul_f32 v151, v151, v119
    v_mfma_f32_16x16x32_bf16 v[104:107], v[36:39], a[140:143], v[104:107]
    ds_write_b128 v12, v[84:87] offset:1024
    v_mfma_f32_16x16x32_bf16 v[108:111], v[36:39], a[204:207], v[108:111]
    v_exp_f32 v148, v148
    s_waitcnt vmcnt(11)
    v_mfma_f32_16x16x32_bf16 v[96:99], v[40:43], a[16:19], v[96:99]
    s_add_u32 s64, s10, 0
    buffer_load_dwordx4 v[32:35], v4, s[4:7], s64 offen offset:0 sc1
    v_mfma_f32_16x16x32_bf16 v[100:103], v[40:43], a[80:83], v[100:103]
    v_exp_f32 v149, v149
    v_mfma_f32_16x16x32_bf16 v[104:107], v[40:43], a[144:147], v[104:107]
    ds_write_b128 v12, v[88:91] offset:2048
    v_mfma_f32_16x16x32_bf16 v[108:111], v[40:43], a[208:211], v[108:111]
    v_exp_f32 v150, v150
    s_waitcnt vmcnt(11)
    v_mfma_f32_16x16x32_bf16 v[96:99], v[44:47], a[20:23], v[96:99]
    buffer_load_dwordx4 v[36:39], v4, s[4:7], s64 offen offset:1024 sc1
    v_mfma_f32_16x16x32_bf16 v[100:103], v[44:47], a[84:87], v[100:103]
    v_exp_f32 v151, v151
    v_mfma_f32_16x16x32_bf16 v[104:107], v[44:47], a[148:151], v[104:107]
    ds_write_b128 v12, v[92:95] offset:3072
    v_add_f32 v148, 1.0, v148
    v_mfma_f32_16x16x32_bf16 v[108:111], v[44:47], a[212:215], v[108:111]
    v_add_f32 v149, 1.0, v149
    s_waitcnt vmcnt(11)
    v_mfma_f32_16x16x32_bf16 v[96:99], v[48:51], a[24:27], v[96:99]
    buffer_load_dwordx4 v[40:43], v4, s[4:7], s64 offen offset:2048 sc1
    v_add_f32 v150, 1.0, v150
    v_mfma_f32_16x16x32_bf16 v[100:103], v[48:51], a[88:91], v[100:103]
    v_add_f32 v151, 1.0, v151
    v_mfma_f32_16x16x32_bf16 v[104:107], v[48:51], a[152:155], v[104:107]
    v_rcp_f32 v148, v148
    v_mfma_f32_16x16x32_bf16 v[108:111], v[48:51], a[216:219], v[108:111]
    v_rcp_f32 v149, v149
    s_waitcnt vmcnt(11)
    v_mfma_f32_16x16x32_bf16 v[96:99], v[52:55], a[28:31], v[96:99]
    buffer_load_dwordx4 v[44:47], v4, s[4:7], s64 offen offset:3072 sc1
    v_mfma_f32_16x16x32_bf16 v[100:103], v[52:55], a[92:95], v[100:103]
    v_rcp_f32 v150, v150
    v_mfma_f32_16x16x32_bf16 v[104:107], v[52:55], a[156:159], v[104:107]
    v_rcp_f32 v151, v151
    v_mfma_f32_16x16x32_bf16 v[108:111], v[52:55], a[220:223], v[108:111]
    v_mul_f32 v116, v116, v148
    s_waitcnt vmcnt(11)
    v_mfma_f32_16x16x32_bf16 v[96:99], v[56:59], a[32:35], v[96:99]
    s_add_u32 s64, s10, 4096
    buffer_load_dwordx4 v[48:51], v4, s[4:7], s64 offen offset:0 sc1
    v_mfma_f32_16x16x32_bf16 v[100:103], v[56:59], a[96:99], v[100:103]
    v_mul_f32 v117, v117, v149
    v_mul_f32 v118, v118, v150
    v_mfma_f32_16x16x32_bf16 v[104:107], v[56:59], a[160:163], v[104:107]
    v_mul_f32 v119, v119, v151
    v_mul_f32 v144, v120, v120
    v_mfma_f32_16x16x32_bf16 v[108:111], v[56:59], a[224:227], v[108:111]
    v_mul_f32 v145, v121, v121
    s_waitcnt vmcnt(11)
    v_mfma_f32_16x16x32_bf16 v[96:99], v[60:63], a[36:39], v[96:99]
    buffer_load_dwordx4 v[52:55], v4, s[4:7], s64 offen offset:1024 sc1
    v_mul_f32 v146, v122, v122
    v_mfma_f32_16x16x32_bf16 v[100:103], v[60:63], a[100:103], v[100:103]
    v_mul_f32_e64 v147, v123, v123
    v_fma_f32 v144, v144, s58, v152
    v_mfma_f32_16x16x32_bf16 v[104:107], v[60:63], a[164:167], v[104:107]
    v_fma_f32 v145, v145, s58, v152
    v_fma_f32 v146, v146, s58, v152
    v_mfma_f32_16x16x32_bf16 v[108:111], v[60:63], a[228:231], v[108:111]
    v_fma_f32 v147, v147, s58, v152
    s_waitcnt vmcnt(11)
    v_mfma_f32_16x16x32_bf16 v[96:99], v[64:67], a[40:43], v[96:99]
    buffer_load_dwordx4 v[56:59], v4, s[4:7], s64 offen offset:2048 sc1
    v_mul_f32 v144, v144, v120
    v_mfma_f32_16x16x32_bf16 v[100:103], v[64:67], a[104:107], v[100:103]
    v_mul_f32 v145, v145, v121
    v_mul_f32 v146, v146, v122
    v_mfma_f32_16x16x32_bf16 v[104:107], v[64:67], a[168:171], v[104:107]
    v_mul_f32 v147, v147, v123
    v_mfma_f32_16x16x32_bf16 v[108:111], v[64:67], a[232:235], v[108:111]
    v_exp_f32 v144, v144
    s_waitcnt vmcnt(11)
    v_mfma_f32_16x16x32_bf16 v[96:99], v[68:71], a[44:47], v[96:99]
    buffer_load_dwordx4 v[60:63], v4, s[4:7], s64 offen offset:3072 sc1
    v_mfma_f32_16x16x32_bf16 v[100:103], v[68:71], a[108:111], v[100:103]
    v_exp_f32 v145, v145
    v_mfma_f32_16x16x32_bf16 v[104:107], v[68:71], a[172:175], v[104:107]
    v_exp_f32 v146, v146
    v_mfma_f32_16x16x32_bf16 v[108:111], v[68:71], a[236:239], v[108:111]
    v_exp_f32 v147, v147
    s_waitcnt vmcnt(11)
    v_mfma_f32_16x16x32_bf16 v[96:99], v[16:19], a[48:51], v[96:99]
    s_add_u32 s64, s10, 8192
    buffer_load_dwordx4 v[64:67], v4, s[4:7], s64 offen offset:0 sc1
    v_mfma_f32_16x16x32_bf16 v[100:103], v[16:19], a[112:115], v[100:103]
    v_add_f32 v144, 1.0, v144
    v_add_f32 v145, 1.0, v145
    v_mfma_f32_16x16x32_bf16 v[104:107], v[16:19], a[176:179], v[104:107]
    v_add_f32 v146, 1.0, v146
    v_add_f32 v147, 1.0, v147
    v_mfma_f32_16x16x32_bf16 v[108:111], v[16:19], a[240:243], v[108:111]
    v_rcp_f32 v144, v144
    s_waitcnt vmcnt(11)
    v_mfma_f32_16x16x32_bf16 v[96:99], v[20:23], a[52:55], v[96:99]
    buffer_load_dwordx4 v[68:71], v4, s[4:7], s64 offen offset:1024 sc1
    v_mfma_f32_16x16x32_bf16 v[100:103], v[20:23], a[116:119], v[100:103]
    v_rcp_f32 v145, v145
    v_mfma_f32_16x16x32_bf16 v[104:107], v[20:23], a[180:183], v[104:107]
    v_rcp_f32 v146, v146
    v_mfma_f32_16x16x32_bf16 v[108:111], v[20:23], a[244:247], v[108:111]
    v_rcp_f32 v147, v147
    s_waitcnt vmcnt(11)
    v_mfma_f32_16x16x32_bf16 v[96:99], v[24:27], a[56:59], v[96:99]
    buffer_load_dwordx4 v[16:19], v4, s[4:7], s64 offen offset:2048 sc1
    v_mul_f32 v120, v120, v144
    v_mfma_f32_16x16x32_bf16 v[100:103], v[24:27], a[120:123], v[100:103]
    v_mul_f32 v121, v121, v145
    v_mul_f32 v122, v122, v146
    v_mfma_f32_16x16x32_bf16 v[104:107], v[24:27], a[184:187], v[104:107]
    v_mul_f32 v123, v123, v147
    v_mul_f32 v148, v124, v124
    v_mfma_f32_16x16x32_bf16 v[108:111], v[24:27], a[248:251], v[108:111]
    v_mul_f32 v149, v125, v125
    s_waitcnt vmcnt(11)
    v_mfma_f32_16x16x32_bf16 v[96:99], v[28:31], a[60:63], v[96:99]
    buffer_load_dwordx4 v[20:23], v4, s[4:7], s64 offen offset:3072 sc1
    v_mul_f32 v150, v126, v126
    v_mfma_f32_16x16x32_bf16 v[100:103], v[28:31], a[124:127], v[100:103]
    v_mul_f32 v151, v127, v127
    v_fma_f32 v148, v148, s58, v152
    v_mfma_f32_16x16x32_bf16 v[104:107], v[28:31], a[188:191], v[104:107]
    v_fma_f32 v149, v149, s58, v152
    v_fma_f32 v150, v150, s58, v152
    v_mfma_f32_16x16x32_bf16 v[108:111], v[28:31], a[252:255], v[108:111]
    v_fma_f32 v151, v151, s58, v152
    s_waitcnt vmcnt(11)
    v_mfma_f32_16x16x32_bf16 v[80:83], v[32:35], a[0:3], 0
    s_add_u32 s64, s10, 12288
    buffer_load_dwordx4 v[24:27], v4, s[4:7], s64 offen offset:0 sc1
    v_mfma_f32_16x16x32_bf16 v[84:87], v[32:35], a[64:67], 0
    v_mul_f32 v148, v148, v124
    v_mul_f32 v149, v149, v125
    v_mfma_f32_16x16x32_bf16 v[88:91], v[32:35], a[128:131], 0
    v_mul_f32 v150, v150, v126
    v_mul_f32 v151, v151, v127
    v_mfma_f32_16x16x32_bf16 v[92:95], v[32:35], a[192:195], 0
    v_exp_f32 v148, v148
    s_waitcnt vmcnt(11)
    v_mfma_f32_16x16x32_bf16 v[80:83], v[36:39], a[4:7], v[80:83]
    buffer_load_dwordx4 v[28:31], v4, s[4:7], s64 offen offset:1024 sc1
    v_mfma_f32_16x16x32_bf16 v[84:87], v[36:39], a[68:71], v[84:87]
    v_exp_f32 v149, v149
    v_mfma_f32_16x16x32_bf16 v[88:91], v[36:39], a[132:135], v[88:91]
    v_exp_f32 v150, v150
    v_mfma_f32_16x16x32_bf16 v[92:95], v[36:39], a[196:199], v[92:95]
    v_exp_f32 v151, v151
    s_waitcnt vmcnt(11)
    v_mfma_f32_16x16x32_bf16 v[80:83], v[40:43], a[8:11], v[80:83]
    buffer_load_dwordx4 v[32:35], v4, s[4:7], s64 offen offset:2048 sc1
    v_add_f32 v148, 1.0, v148
    v_mfma_f32_16x16x32_bf16 v[84:87], v[40:43], a[72:75], v[84:87]
    v_add_f32 v149, 1.0, v149
    v_add_f32 v150, 1.0, v150
    v_mfma_f32_16x16x32_bf16 v[88:91], v[40:43], a[136:139], v[88:91]
    ds_write_b128 v12, v[96:99] offset:4096
    v_add_f32 v151, 1.0, v151
    v_mfma_f32_16x16x32_bf16 v[92:95], v[40:43], a[200:203], v[92:95]
    v_rcp_f32 v148, v148
    s_waitcnt vmcnt(11)
    v_mfma_f32_16x16x32_bf16 v[80:83], v[44:47], a[12:15], v[80:83]
    buffer_load_dwordx4 v[36:39], v4, s[4:7], s64 offen offset:3072 sc1
    v_mfma_f32_16x16x32_bf16 v[84:87], v[44:47], a[76:79], v[84:87]
    v_rcp_f32 v149, v149
    v_mfma_f32_16x16x32_bf16 v[88:91], v[44:47], a[140:143], v[88:91]
    ds_write_b128 v12, v[100:103] offset:5120
    v_mfma_f32_16x16x32_bf16 v[92:95], v[44:47], a[204:207], v[92:95]
    v_rcp_f32 v150, v150
    s_waitcnt vmcnt(11)
    v_mfma_f32_16x16x32_bf16 v[80:83], v[48:51], a[16:19], v[80:83]
    s_add_u32 s64, s11, 0
    buffer_load_dwordx4 v[40:43], v4, s[4:7], s64 offen offset:0 sc1
    v_mfma_f32_16x16x32_bf16 v[84:87], v[48:51], a[80:83], v[84:87]
    v_rcp_f32 v151, v151
    v_mfma_f32_16x16x32_bf16 v[88:91], v[48:51], a[144:147], v[88:91]
    ds_write_b128 v12, v[104:107] offset:6144
    v_mul_f32 v124, v124, v148
    v_mfma_f32_16x16x32_bf16 v[92:95], v[48:51], a[208:211], v[92:95]
    v_mul_f32 v125, v125, v149
    s_waitcnt vmcnt(11)
    v_mfma_f32_16x16x32_bf16 v[80:83], v[52:55], a[20:23], v[80:83]
    buffer_load_dwordx4 v[44:47], v4, s[4:7], s64 offen offset:1024 sc1
    v_mul_f32 v126, v126, v150
    v_mfma_f32_16x16x32_bf16 v[84:87], v[52:55], a[84:87], v[84:87]
    v_mul_f32 v127, v127, v151
    v_mul_f32 v144, v128, v128
    v_mfma_f32_16x16x32_bf16 v[88:91], v[52:55], a[148:151], v[88:91]
    ds_write_b128 v12, v[108:111] offset:7168
    v_mul_f32 v145, v129, v129
    v_mfma_f32_16x16x32_bf16 v[92:95], v[52:55], a[212:215], v[92:95]
    v_mul_f32 v146, v130, v130
    s_waitcnt vmcnt(11)
    v_mfma_f32_16x16x32_bf16 v[80:83], v[56:59], a[24:27], v[80:83]
    buffer_load_dwordx4 v[48:51], v4, s[4:7], s64 offen offset:2048 sc1
    v_mul_f32 v147, v131, v131
    v_mfma_f32_16x16x32_bf16 v[84:87], v[56:59], a[88:91], v[84:87]
    v_fma_f32 v144, v144, s58, v152
    v_fma_f32 v145, v145, s58, v152
    v_mfma_f32_16x16x32_bf16 v[88:91], v[56:59], a[152:155], v[88:91]
    v_fma_f32 v146, v146, s58, v152
    v_fma_f32 v147, v147, s58, v152
    v_mfma_f32_16x16x32_bf16 v[92:95], v[56:59], a[216:219], v[92:95]
    v_mul_f32 v144, v144, v128
    s_waitcnt vmcnt(11)
    v_mfma_f32_16x16x32_bf16 v[80:83], v[60:63], a[28:31], v[80:83]
    buffer_load_dwordx4 v[52:55], v4, s[4:7], s64 offen offset:3072 sc1
    v_mul_f32 v145, v145, v129
    v_mfma_f32_16x16x32_bf16 v[84:87], v[60:63], a[92:95], v[84:87]
    v_mul_f32 v146, v146, v130
    v_mul_f32 v147, v147, v131
    v_mfma_f32_16x16x32_bf16 v[88:91], v[60:63], a[156:159], v[88:91]
    v_exp_f32 v144, v144
    v_mfma_f32_16x16x32_bf16 v[92:95], v[60:63], a[220:223], v[92:95]
    v_exp_f32 v145, v145
    s_waitcnt vmcnt(11)
    v_mfma_f32_16x16x32_bf16 v[80:83], v[64:67], a[32:35], v[80:83]
    s_add_u32 s64, s11, 4096
    buffer_load_dwordx4 v[56:59], v4, s[4:7], s64 offen offset:0 sc1
    v_mfma_f32_16x16x32_bf16 v[84:87], v[64:67], a[96:99], v[84:87]
    v_exp_f32 v146, v146
    v_mfma_f32_16x16x32_bf16 v[88:91], v[64:67], a[160:163], v[88:91]
    v_exp_f32 v147, v147
    v_mfma_f32_16x16x32_bf16 v[92:95], v[64:67], a[224:227], v[92:95]
    v_add_f32 v144, 1.0, v144
    s_waitcnt vmcnt(11)
    v_mfma_f32_16x16x32_bf16 v[80:83], v[68:71], a[36:39], v[80:83]
    buffer_load_dwordx4 v[60:63], v4, s[4:7], s64 offen offset:1024 sc1
    v_add_f32 v145, 1.0, v145
    v_mfma_f32_16x16x32_bf16 v[84:87], v[68:71], a[100:103], v[84:87]
    v_add_f32 v146, 1.0, v146
    v_add_f32 v147, 1.0, v147
    v_mfma_f32_16x16x32_bf16 v[88:91], v[68:71], a[164:167], v[88:91]
    v_rcp_f32 v144, v144
    v_mfma_f32_16x16x32_bf16 v[92:95], v[68:71], a[228:231], v[92:95]
    v_rcp_f32 v145, v145
    s_waitcnt vmcnt(11)
    v_mfma_f32_16x16x32_bf16 v[80:83], v[16:19], a[40:43], v[80:83]
    buffer_load_dwordx4 v[64:67], v4, s[4:7], s64 offen offset:2048 sc1
    v_mfma_f32_16x16x32_bf16 v[84:87], v[16:19], a[104:107], v[84:87]
    v_rcp_f32 v146, v146
    v_mfma_f32_16x16x32_bf16 v[88:91], v[16:19], a[168:171], v[88:91]
    v_rcp_f32 v147, v147
    v_mfma_f32_16x16x32_bf16 v[92:95], v[16:19], a[232:235], v[92:95]
    v_mul_f32 v128, v128, v144
    s_waitcnt vmcnt(11)
    v_mfma_f32_16x16x32_bf16 v[80:83], v[20:23], a[44:47], v[80:83]
    buffer_load_dwordx4 v[68:71], v4, s[4:7], s64 offen offset:3072 sc1
    v_mul_f32 v129, v129, v145
    v_mfma_f32_16x16x32_bf16 v[84:87], v[20:23], a[108:111], v[84:87]
    v_mul_f32 v130, v130, v146
    v_mul_f32 v131, v131, v147
    v_mfma_f32_16x16x32_bf16 v[88:91], v[20:23], a[172:175], v[88:91]
    v_mul_f32 v148, v132, v132
    v_mul_f32 v149, v133, v133
    v_mfma_f32_16x16x32_bf16 v[92:95], v[20:23], a[236:239], v[92:95]
    v_mul_f32 v150, v134, v134
    s_waitcnt vmcnt(11)
    v_mfma_f32_16x16x32_bf16 v[80:83], v[24:27], a[48:51], v[80:83]
    s_add_u32 s64, s11, 8192
    buffer_load_dwordx4 v[16:19], v4, s[4:7], s64 offen offset:0 sc1
    v_mfma_f32_16x16x32_bf16 v[84:87], v[24:27], a[112:115], v[84:87]
    v_mul_f32 v151, v135, v135
    v_fma_f32 v148, v148, s58, v152
    v_mfma_f32_16x16x32_bf16 v[88:91], v[24:27], a[176:179], v[88:91]
    v_fma_f32 v149, v149, s58, v152
    v_fma_f32 v150, v150, s58, v152
    v_mfma_f32_16x16x32_bf16 v[92:95], v[24:27], a[240:243], v[92:95]
    v_fma_f32 v151, v151, s58, v152
    s_waitcnt vmcnt(11)
    v_mfma_f32_16x16x32_bf16 v[80:83], v[28:31], a[52:55], v[80:83]
    buffer_load_dwordx4 v[20:23], v4, s[4:7], s64 offen offset:1024 sc1
    v_mul_f32 v148, v148, v132
    v_mfma_f32_16x16x32_bf16 v[84:87], v[28:31], a[116:119], v[84:87]
    v_mul_f32 v149, v149, v133
    v_mul_f32 v150, v150, v134
    v_mfma_f32_16x16x32_bf16 v[88:91], v[28:31], a[180:183], v[88:91]
    v_mul_f32 v151, v151, v135
    v_mfma_f32_16x16x32_bf16 v[92:95], v[28:31], a[244:247], v[92:95]
    v_exp_f32 v148, v148
    s_waitcnt vmcnt(11)
    v_mfma_f32_16x16x32_bf16 v[80:83], v[32:35], a[56:59], v[80:83]
    buffer_load_dwordx4 v[24:27], v4, s[4:7], s64 offen offset:2048 sc1
    v_mfma_f32_16x16x32_bf16 v[84:87], v[32:35], a[120:123], v[84:87]
    v_exp_f32 v149, v149
    v_mfma_f32_16x16x32_bf16 v[88:91], v[32:35], a[184:187], v[88:91]
    v_exp_f32 v150, v150
    v_mfma_f32_16x16x32_bf16 v[92:95], v[32:35], a[248:251], v[92:95]
    v_exp_f32 v151, v151
    s_waitcnt vmcnt(11)
    v_mfma_f32_16x16x32_bf16 v[80:83], v[36:39], a[60:63], v[80:83]
    buffer_load_dwordx4 v[28:31], v4, s[4:7], s64 offen offset:3072 sc1
    v_add_f32 v148, 1.0, v148
    v_mfma_f32_16x16x32_bf16 v[84:87], v[36:39], a[124:127], v[84:87]
    v_add_f32 v149, 1.0, v149
    v_add_f32 v150, 1.0, v150
    v_mfma_f32_16x16x32_bf16 v[88:91], v[36:39], a[188:191], v[88:91]
    v_add_f32 v151, 1.0, v151
    v_mfma_f32_16x16x32_bf16 v[92:95], v[36:39], a[252:255], v[92:95]
    v_rcp_f32 v148, v148
    s_waitcnt vmcnt(11)
    v_mfma_f32_16x16x32_bf16 v[96:99], v[40:43], a[0:3], 0
    s_add_u32 s64, s11, 12288
    buffer_load_dwordx4 v[32:35], v4, s[4:7], s64 offen offset:0 sc1
    v_mfma_f32_16x16x32_bf16 v[100:103], v[40:43], a[64:67], 0
    v_rcp_f32 v149, v149
    v_mfma_f32_16x16x32_bf16 v[104:107], v[40:43], a[128:131], 0
    v_rcp_f32 v150, v150
    v_mfma_f32_16x16x32_bf16 v[108:111], v[40:43], a[192:195], 0
    v_rcp_f32 v151, v151
    s_waitcnt vmcnt(11)
    v_mfma_f32_16x16x32_bf16 v[96:99], v[44:47], a[4:7], v[96:99]
    buffer_load_dwordx4 v[36:39], v4, s[4:7], s64 offen offset:1024 sc1
    v_mul_f32 v132, v132, v148
    v_mfma_f32_16x16x32_bf16 v[100:103], v[44:47], a[68:71], v[100:103]
    v_mul_f32 v133, v133, v149
    v_mul_f32 v134, v134, v150
    v_mfma_f32_16x16x32_bf16 v[104:107], v[44:47], a[132:135], v[104:107]
    v_mul_f32 v135, v135, v151
    v_mul_f32 v144, v136, v136
    v_mfma_f32_16x16x32_bf16 v[108:111], v[44:47], a[196:199], v[108:111]
    v_mul_f32 v145, v137, v137
    s_waitcnt vmcnt(11)
    v_mfma_f32_16x16x32_bf16 v[96:99], v[48:51], a[8:11], v[96:99]
    buffer_load_dwordx4 v[40:43], v4, s[4:7], s64 offen offset:2048 sc1
    v_mul_f32 v146, v138, v138
    v_mfma_f32_16x16x32_bf16 v[100:103], v[48:51], a[72:75], v[100:103]
    v_mul_f32 v147, v139, v139
    v_fma_f32 v144, v144, s58, v152
    v_mfma_f32_16x16x32_bf16 v[104:107], v[48:51], a[136:139], v[104:107]
    ds_write_b128 v12, v[80:83] offset:8192
    v_fma_f32 v145, v145, s58, v152
    v_mfma_f32_16x16x32_bf16 v[108:111], v[48:51], a[200:203], v[108:111]
    v_fma_f32 v146, v146, s58, v152
    s_waitcnt vmcnt(11)
    v_mfma_f32_16x16x32_bf16 v[96:99], v[52:55], a[12:15], v[96:99]
    buffer_load_dwordx4 v[44:47], v4, s[4:7], s64 offen offset:3072 sc1
    v_fma_f32 v147, v147, s58, v152
    v_mfma_f32_16x16x32_bf16 v[100:103], v[52:55], a[76:79], v[100:103]
    v_mul_f32 v144, v144, v136
    v_mul_f32 v145, v145, v137
    v_mfma_f32_16x16x32_bf16 v[104:107], v[52:55], a[140:143], v[104:107]
    ds_write_b128 v12, v[84:87] offset:9216
    v_mul_f32 v146, v146, v138
    v_mfma_f32_16x16x32_bf16 v[108:111], v[52:55], a[204:207], v[108:111]
    v_mul_f32 v147, v147, v139
    s_waitcnt vmcnt(11)
    v_mfma_f32_16x16x32_bf16 v[96:99], v[56:59], a[16:19], v[96:99]
    s_add_u32 s64, s12, 0
    buffer_load_dwordx4 v[48:51], v4, s[4:7], s64 offen offset:0 sc1
    v_mfma_f32_16x16x32_bf16 v[100:103], v[56:59], a[80:83], v[100:103]
    v_exp_f32 v144, v144
    v_mfma_f32_16x16x32_bf16 v[104:107], v[56:59], a[144:147], v[104:107]
    ds_write_b128 v12, v[88:91] offset:10240
    v_mfma_f32_16x16x32_bf16 v[108:111], v[56:59], a[208:211], v[108:111]
    v_exp_f32 v145, v145
    s_waitcnt vmcnt(11)
    v_mfma_f32_16x16x32_bf16 v[96:99], v[60:63], a[20:23], v[96:99]
    buffer_load_dwordx4 v[52:55], v4, s[4:7], s64 offen offset:1024 sc1
    v_mfma_f32_16x16x32_bf16 v[100:103], v[60:63], a[84:87], v[100:103]
    v_exp_f32 v146, v146
    v_mfma_f32_16x16x32_bf16 v[104:107], v[60:63], a[148:151], v[104:107]
    ds_write_b128 v12, v[92:95] offset:11264
    v_mfma_f32_16x16x32_bf16 v[108:111], v[60:63], a[212:215], v[108:111]
    v_exp_f32 v147, v147
    s_waitcnt vmcnt(11)
    v_mfma_f32_16x16x32_bf16 v[96:99], v[64:67], a[24:27], v[96:99]
    buffer_load_dwordx4 v[56:59], v4, s[4:7], s64 offen offset:2048 sc1
    v_add_f32 v144, 1.0, v144
    v_mfma_f32_16x16x32_bf16 v[100:103], v[64:67], a[88:91], v[100:103]
    v_add_f32 v145, 1.0, v145
    v_add_f32 v146, 1.0, v146
    v_mfma_f32_16x16x32_bf16 v[104:107], v[64:67], a[152:155], v[104:107]
    v_add_f32 v147, 1.0, v147
    v_mfma_f32_16x16x32_bf16 v[108:111], v[64:67], a[216:219], v[108:111]
    v_rcp_f32 v144, v144
    s_waitcnt vmcnt(11)
    v_mfma_f32_16x16x32_bf16 v[96:99], v[68:71], a[28:31], v[96:99]
    buffer_load_dwordx4 v[60:63], v4, s[4:7], s64 offen offset:3072 sc1
    v_mfma_f32_16x16x32_bf16 v[100:103], v[68:71], a[92:95], v[100:103]
    v_rcp_f32 v145, v145
    v_mfma_f32_16x16x32_bf16 v[104:107], v[68:71], a[156:159], v[104:107]
    v_rcp_f32 v146, v146
    v_mfma_f32_16x16x32_bf16 v[108:111], v[68:71], a[220:223], v[108:111]
    v_rcp_f32 v147, v147
    s_waitcnt vmcnt(11)
    v_mfma_f32_16x16x32_bf16 v[96:99], v[16:19], a[32:35], v[96:99]
    s_add_u32 s64, s12, 4096
    buffer_load_dwordx4 v[64:67], v4, s[4:7], s64 offen offset:0 sc1
    v_mfma_f32_16x16x32_bf16 v[100:103], v[16:19], a[96:99], v[100:103]
    v_mul_f32 v136, v136, v144
    v_mul_f32 v137, v137, v145
    v_mfma_f32_16x16x32_bf16 v[104:107], v[16:19], a[160:163], v[104:107]
    v_mul_f32 v138, v138, v146
    v_mul_f32 v139, v139, v147
    v_mfma_f32_16x16x32_bf16 v[108:111], v[16:19], a[224:227], v[108:111]
    v_mul_f32 v148, v140, v140
    s_waitcnt vmcnt(11)
    v_mfma_f32_16x16x32_bf16 v[96:99], v[20:23], a[36:39], v[96:99]
    buffer_load_dwordx4 v[68:71], v4, s[4:7], s64 offen offset:1024 sc1
    v_mul_f32 v149, v141, v141
    v_mfma_f32_16x16x32_bf16 v[100:103], v[20:23], a[100:103], v[100:103]
    v_mul_f32 v150, v142, v142
    v_mul_f32 v151, v143, v143
    v_mfma_f32_16x16x32_bf16 v[104:107], v[20:23], a[164:167], v[104:107]
    v_fma_f32 v148, v148, s58, v152
    v_fma_f32 v149, v149, s58, v152
    v_mfma_f32_16x16x32_bf16 v[108:111], v[20:23], a[228:231], v[108:111]
    v_fma_f32 v150, v150, s58, v152
    s_waitcnt vmcnt(11)
    v_mfma_f32_16x16x32_bf16 v[96:99], v[24:27], a[40:43], v[96:99]
    buffer_load_dwordx4 v[16:19], v4, s[4:7], s64 offen offset:2048 sc1
    v_fma_f32 v151, v151, s58, v152
    v_mfma_f32_16x16x32_bf16 v[100:103], v[24:27], a[104:107], v[100:103]
    v_mul_f32 v148, v148, v140
    v_mul_f32 v149, v149, v141
    v_mfma_f32_16x16x32_bf16 v[104:107], v[24:27], a[168:171], v[104:107]
    v_mul_f32 v150, v150, v142
    v_mul_f32 v151, v151, v143
    v_mfma_f32_16x16x32_bf16 v[108:111], v[24:27], a[232:235], v[108:111]
    v_exp_f32 v148, v148
    s_waitcnt vmcnt(11)
    v_mfma_f32_16x16x32_bf16 v[96:99], v[28:31], a[44:47], v[96:99]
    buffer_load_dwordx4 v[20:23], v4, s[4:7], s64 offen offset:3072 sc1
    v_mfma_f32_16x16x32_bf16 v[100:103], v[28:31], a[108:111], v[100:103]
    v_exp_f32 v149, v149
    v_mfma_f32_16x16x32_bf16 v[104:107], v[28:31], a[172:175], v[104:107]
    v_exp_f32 v150, v150
    v_mfma_f32_16x16x32_bf16 v[108:111], v[28:31], a[236:239], v[108:111]
    v_exp_f32 v151, v151
    s_waitcnt vmcnt(11)
    v_mfma_f32_16x16x32_bf16 v[96:99], v[32:35], a[48:51], v[96:99]
    s_add_u32 s64, s12, 8192
    buffer_load_dwordx4 v[24:27], v4, s[4:7], s64 offen offset:0 sc1
    v_mfma_f32_16x16x32_bf16 v[100:103], v[32:35], a[112:115], v[100:103]
    v_add_f32 v148, 1.0, v148
    v_add_f32 v149, 1.0, v149
    v_mfma_f32_16x16x32_bf16 v[104:107], v[32:35], a[176:179], v[104:107]
    v_add_f32 v150, 1.0, v150
    v_add_f32 v151, 1.0, v151
    v_mfma_f32_16x16x32_bf16 v[108:111], v[32:35], a[240:243], v[108:111]
    v_rcp_f32 v148, v148
    s_waitcnt vmcnt(11)
    v_mfma_f32_16x16x32_bf16 v[96:99], v[36:39], a[52:55], v[96:99]
    buffer_load_dwordx4 v[28:31], v4, s[4:7], s64 offen offset:1024 sc1
    v_mfma_f32_16x16x32_bf16 v[100:103], v[36:39], a[116:119], v[100:103]
    v_rcp_f32 v149, v149
    v_mfma_f32_16x16x32_bf16 v[104:107], v[36:39], a[180:183], v[104:107]
    v_rcp_f32 v150, v150
    v_mfma_f32_16x16x32_bf16 v[108:111], v[36:39], a[244:247], v[108:111]
    v_rcp_f32 v151, v151
    s_waitcnt vmcnt(11)
    v_mfma_f32_16x16x32_bf16 v[96:99], v[40:43], a[56:59], v[96:99]
    buffer_load_dwordx4 v[32:35], v4, s[4:7], s64 offen offset:2048 sc1
    v_mul_f32 v140, v140, v148
    v_mfma_f32_16x16x32_bf16 v[100:103], v[40:43], a[120:123], v[100:103]
    v_mul_f32 v141, v141, v149
    v_mul_f32 v142, v142, v150
    v_mfma_f32_16x16x32_bf16 v[104:107], v[40:43], a[184:187], v[104:107]
    v_mul_f32 v143, v143, v151
    v_lshlrev_b32 v224, 16, v8
    v_mfma_f32_16x16x32_bf16 v[108:111], v[40:43], a[248:251], v[108:111]
    v_lshlrev_b32 v225, 16, v8
    s_waitcnt vmcnt(11)
    v_mfma_f32_16x16x32_bf16 v[96:99], v[44:47], a[60:63], v[96:99]
    buffer_load_dwordx4 v[36:39], v4, s[4:7], s64 offen offset:3072 sc1
    v_lshlrev_b32 v226, 16, v8
    v_mfma_f32_16x16x32_bf16 v[100:103], v[44:47], a[124:127], v[100:103]
    v_lshlrev_b32 v227, 16, v8
    v_lshlrev_b32 v228, 16, v9
    v_mfma_f32_16x16x32_bf16 v[104:107], v[44:47], a[188:191], v[104:107]
    v_lshlrev_b32 v229, 16, v9
    v_lshlrev_b32 v230, 16, v9
    v_mfma_f32_16x16x32_bf16 v[108:111], v[44:47], a[252:255], v[108:111]
    v_lshlrev_b32 v231, 16, v9
    s_waitcnt vmcnt(11)
    v_mfma_f32_16x16x32_bf16 v[80:83], v[48:51], a[0:3], 0
    s_add_u32 s64, s12, 12288
    buffer_load_dwordx4 v[40:43], v4, s[4:7], s64 offen offset:0 sc1
    v_mfma_f32_16x16x32_bf16 v[84:87], v[48:51], a[64:67], 0
    v_lshlrev_b32 v232, 16, v10
    v_lshlrev_b32 v233, 16, v10
    v_mfma_f32_16x16x32_bf16 v[88:91], v[48:51], a[128:131], 0
    v_lshlrev_b32 v234, 16, v10
    v_lshlrev_b32 v235, 16, v10
    v_mfma_f32_16x16x32_bf16 v[92:95], v[48:51], a[192:195], 0
    v_lshlrev_b32 v236, 16, v11
    s_waitcnt vmcnt(11)
    v_mfma_f32_16x16x32_bf16 v[80:83], v[52:55], a[4:7], v[80:83]
    buffer_load_dwordx4 v[44:47], v4, s[4:7], s64 offen offset:1024 sc1
    v_lshlrev_b32 v237, 16, v11
    v_mfma_f32_16x16x32_bf16 v[84:87], v[52:55], a[68:71], v[84:87]
    v_lshlrev_b32 v238, 16, v11
    v_lshlrev_b32 v239, 16, v11
    v_mfma_f32_16x16x32_bf16 v[88:91], v[52:55], a[132:135], v[88:91]
    v_mul_f32 v192, s78, v224
    v_mul_f32 v193, s78, v225
    v_mfma_f32_16x16x32_bf16 v[92:95], v[52:55], a[196:199], v[92:95]
    v_mul_f32 v194, s78, v226
    s_waitcnt vmcnt(11)
    v_mfma_f32_16x16x32_bf16 v[80:83], v[56:59], a[8:11], v[80:83]
    buffer_load_dwordx4 v[48:51], v4, s[4:7], s64 offen offset:2048 sc1
    v_mul_f32 v195, s78, v227
    v_mfma_f32_16x16x32_bf16 v[84:87], v[56:59], a[72:75], v[84:87]
    v_mul_f32 v196, s78, v228
    v_mul_f32 v197, s78, v229
    v_mfma_f32_16x16x32_bf16 v[88:91], v[56:59], a[136:139], v[88:91]
    ds_write_b128 v12, v[96:99] offset:12288
    v_mul_f32 v198, s78, v230
    v_mfma_f32_16x16x32_bf16 v[92:95], v[56:59], a[200:203], v[92:95]
    v_mul_f32 v199, s78, v231
    s_waitcnt vmcnt(11)
    v_mfma_f32_16x16x32_bf16 v[80:83], v[60:63], a[12:15], v[80:83]
    buffer_load_dwordx4 v[52:55], v4, s[4:7], s64 offen offset:3072 sc1
    v_mul_f32 v200, s78, v232
    v_mfma_f32_16x16x32_bf16 v[84:87], v[60:63], a[76:79], v[84:87]
    v_mul_f32 v201, s78, v233
    v_mul_f32 v202, s78, v234
    v_mfma_f32_16x16x32_bf16 v[88:91], v[60:63], a[140:143], v[88:91]
    ds_write_b128 v12, v[100:103] offset:13312
    v_mul_f32 v203, s78, v235
    v_mfma_f32_16x16x32_bf16 v[92:95], v[60:63], a[204:207], v[92:95]
    v_mul_f32 v204, s78, v236
    s_waitcnt vmcnt(11)
    v_mfma_f32_16x16x32_bf16 v[80:83], v[64:67], a[16:19], v[80:83]
    s_add_u32 s64, s13, 0
    buffer_load_dwordx4 v[56:59], v4, s[4:7], s64 offen offset:0 sc1
    v_mfma_f32_16x16x32_bf16 v[84:87], v[64:67], a[80:83], v[84:87]
    v_mul_f32 v205, s78, v237
    v_mul_f32 v206, s78, v238
    v_mfma_f32_16x16x32_bf16 v[88:91], v[64:67], a[144:147], v[88:91]
    ds_write_b128 v12, v[104:107] offset:14336
    v_mul_f32 v207, s78, v239
    v_mfma_f32_16x16x32_bf16 v[92:95], v[64:67], a[208:211], v[92:95]
    s_waitcnt vmcnt(11)
    v_mfma_f32_16x16x32_bf16 v[80:83], v[68:71], a[20:23], v[80:83]
    buffer_load_dwordx4 v[60:63], v4, s[4:7], s64 offen offset:1024 sc1
    v_mfma_f32_16x16x32_bf16 v[84:87], v[68:71], a[84:87], v[84:87]
    v_mfma_f32_16x16x32_bf16 v[88:91], v[68:71], a[148:151], v[88:91]
    ds_write_b128 v12, v[108:111] offset:15360
    v_mfma_f32_16x16x32_bf16 v[92:95], v[68:71], a[212:215], v[92:95]
    s_waitcnt vmcnt(11)
    v_mfma_f32_16x16x32_bf16 v[80:83], v[16:19], a[24:27], v[80:83]
    buffer_load_dwordx4 v[64:67], v4, s[4:7], s64 offen offset:2048 sc1
    v_mfma_f32_16x16x32_bf16 v[84:87], v[16:19], a[88:91], v[84:87]
    v_mfma_f32_16x16x32_bf16 v[88:91], v[16:19], a[152:155], v[88:91]
    v_mfma_f32_16x16x32_bf16 v[92:95], v[16:19], a[216:219], v[92:95]
    s_waitcnt vmcnt(11)
    v_mfma_f32_16x16x32_bf16 v[80:83], v[20:23], a[28:31], v[80:83]
    buffer_load_dwordx4 v[68:71], v4, s[4:7], s64 offen offset:3072 sc1
    v_mfma_f32_16x16x32_bf16 v[84:87], v[20:23], a[92:95], v[84:87]
    v_mfma_f32_16x16x32_bf16 v[88:91], v[20:23], a[156:159], v[88:91]
    v_mfma_f32_16x16x32_bf16 v[92:95], v[20:23], a[220:223], v[92:95]
    s_waitcnt vmcnt(11)
    v_mfma_f32_16x16x32_bf16 v[80:83], v[24:27], a[32:35], v[80:83]
    s_add_u32 s64, s13, 4096
    buffer_load_dwordx4 v[16:19], v4, s[4:7], s64 offen offset:0 sc1
    v_mfma_f32_16x16x32_bf16 v[84:87], v[24:27], a[96:99], v[84:87]
    v_mfma_f32_16x16x32_bf16 v[88:91], v[24:27], a[160:163], v[88:91]
    v_mfma_f32_16x16x32_bf16 v[92:95], v[24:27], a[224:227], v[92:95]
    s_waitcnt vmcnt(11)
    v_mfma_f32_16x16x32_bf16 v[80:83], v[28:31], a[36:39], v[80:83]
    buffer_load_dwordx4 v[20:23], v4, s[4:7], s64 offen offset:1024 sc1
    v_mfma_f32_16x16x32_bf16 v[84:87], v[28:31], a[100:103], v[84:87]
    v_mfma_f32_16x16x32_bf16 v[88:91], v[28:31], a[164:167], v[88:91]
    v_mfma_f32_16x16x32_bf16 v[92:95], v[28:31], a[228:231], v[92:95]
    s_waitcnt vmcnt(11)
    v_mfma_f32_16x16x32_bf16 v[80:83], v[32:35], a[40:43], v[80:83]
    buffer_load_dwordx4 v[24:27], v4, s[4:7], s64 offen offset:2048 sc1
    v_mfma_f32_16x16x32_bf16 v[84:87], v[32:35], a[104:107], v[84:87]
    v_mfma_f32_16x16x32_bf16 v[88:91], v[32:35], a[168:171], v[88:91]
    v_mfma_f32_16x16x32_bf16 v[92:95], v[32:35], a[232:235], v[92:95]
    s_waitcnt vmcnt(11)
    v_mfma_f32_16x16x32_bf16 v[80:83], v[36:39], a[44:47], v[80:83]
    buffer_load_dwordx4 v[28:31], v4, s[4:7], s64 offen offset:3072 sc1
    v_mfma_f32_16x16x32_bf16 v[84:87], v[36:39], a[108:111], v[84:87]
    v_mfma_f32_16x16x32_bf16 v[88:91], v[36:39], a[172:175], v[88:91]
    v_mfma_f32_16x16x32_bf16 v[92:95], v[36:39], a[236:239], v[92:95]
    s_waitcnt vmcnt(11)
    v_mfma_f32_16x16x32_bf16 v[80:83], v[40:43], a[48:51], v[80:83]
    s_add_u32 s64, s13, 8192
    buffer_load_dwordx4 v[32:35], v4, s[4:7], s64 offen offset:0 sc1
    v_mfma_f32_16x16x32_bf16 v[84:87], v[40:43], a[112:115], v[84:87]
    v_mfma_f32_16x16x32_bf16 v[88:91], v[40:43], a[176:179], v[88:91]
    v_mfma_f32_16x16x32_bf16 v[92:95], v[40:43], a[240:243], v[92:95]
    s_waitcnt vmcnt(11)
    v_mfma_f32_16x16x32_bf16 v[80:83], v[44:47], a[52:55], v[80:83]
    buffer_load_dwordx4 v[36:39], v4, s[4:7], s64 offen offset:1024 sc1
    v_mfma_f32_16x16x32_bf16 v[84:87], v[44:47], a[116:119], v[84:87]
    v_mfma_f32_16x16x32_bf16 v[88:91], v[44:47], a[180:183], v[88:91]
    v_mfma_f32_16x16x32_bf16 v[92:95], v[44:47], a[244:247], v[92:95]
    s_waitcnt vmcnt(11)
    v_mfma_f32_16x16x32_bf16 v[80:83], v[48:51], a[56:59], v[80:83]
    buffer_load_dwordx4 v[40:43], v4, s[4:7], s64 offen offset:2048 sc1
    v_mfma_f32_16x16x32_bf16 v[84:87], v[48:51], a[120:123], v[84:87]
    v_mfma_f32_16x16x32_bf16 v[88:91], v[48:51], a[184:187], v[88:91]
    v_mfma_f32_16x16x32_bf16 v[92:95], v[48:51], a[248:251], v[92:95]
    s_waitcnt vmcnt(11)
    v_mfma_f32_16x16x32_bf16 v[80:83], v[52:55], a[60:63], v[80:83]
    buffer_load_dwordx4 v[44:47], v4, s[4:7], s64 offen offset:3072 sc1
    v_mfma_f32_16x16x32_bf16 v[84:87], v[52:55], a[124:127], v[84:87]
    v_mfma_f32_16x16x32_bf16 v[88:91], v[52:55], a[188:191], v[88:91]
    v_mfma_f32_16x16x32_bf16 v[92:95], v[52:55], a[252:255], v[92:95]
    s_waitcnt vmcnt(11)
    v_mfma_f32_16x16x32_bf16 v[96:99], v[56:59], a[0:3], v[192:195]
    s_add_u32 s64, s13, 12288
    buffer_load_dwordx4 v[48:51], v4, s[4:7], s64 offen offset:0 sc1
    v_mfma_f32_16x16x32_bf16 v[100:103], v[56:59], a[64:67], v[196:199]
    v_mfma_f32_16x16x32_bf16 v[104:107], v[56:59], a[128:131], v[200:203]
    v_mfma_f32_16x16x32_bf16 v[108:111], v[56:59], a[192:195], v[204:207]
    s_waitcnt vmcnt(11)
    v_mfma_f32_16x16x32_bf16 v[96:99], v[60:63], a[4:7], v[96:99]
    buffer_load_dwordx4 v[52:55], v4, s[4:7], s64 offen offset:1024 sc1
    v_mfma_f32_16x16x32_bf16 v[100:103], v[60:63], a[68:71], v[100:103]
    v_mfma_f32_16x16x32_bf16 v[104:107], v[60:63], a[132:135], v[104:107]
    v_mfma_f32_16x16x32_bf16 v[108:111], v[60:63], a[196:199], v[108:111]
    s_waitcnt vmcnt(11)
    v_mfma_f32_16x16x32_bf16 v[96:99], v[64:67], a[8:11], v[96:99]
    buffer_load_dwordx4 v[56:59], v4, s[4:7], s64 offen offset:2048 sc1
    v_mfma_f32_16x16x32_bf16 v[100:103], v[64:67], a[72:75], v[100:103]
    v_mfma_f32_16x16x32_bf16 v[104:107], v[64:67], a[136:139], v[104:107]
    ds_write_b128 v12, v[80:83] offset:16384
    v_mfma_f32_16x16x32_bf16 v[108:111], v[64:67], a[200:203], v[108:111]
    s_waitcnt vmcnt(11)
    v_mfma_f32_16x16x32_bf16 v[96:99], v[68:71], a[12:15], v[96:99]
    buffer_load_dwordx4 v[60:63], v4, s[4:7], s64 offen offset:3072 sc1
    v_mfma_f32_16x16x32_bf16 v[100:103], v[68:71], a[76:79], v[100:103]
    v_mfma_f32_16x16x32_bf16 v[104:107], v[68:71], a[140:143], v[104:107]
    ds_write_b128 v12, v[84:87] offset:17408
    v_mfma_f32_16x16x32_bf16 v[108:111], v[68:71], a[204:207], v[108:111]
    s_waitcnt vmcnt(11)
    v_mfma_f32_16x16x32_bf16 v[96:99], v[16:19], a[16:19], v[96:99]
    s_add_u32 s64, s14, 0
    buffer_load_dwordx4 v[64:67], v4, s[4:7], s64 offen offset:0 sc1
    v_mfma_f32_16x16x32_bf16 v[100:103], v[16:19], a[80:83], v[100:103]
    v_mfma_f32_16x16x32_bf16 v[104:107], v[16:19], a[144:147], v[104:107]
    ds_write_b128 v12, v[88:91] offset:18432
    v_mfma_f32_16x16x32_bf16 v[108:111], v[16:19], a[208:211], v[108:111]
    s_waitcnt vmcnt(11)
    v_mfma_f32_16x16x32_bf16 v[96:99], v[20:23], a[20:23], v[96:99]
    buffer_load_dwordx4 v[68:71], v4, s[4:7], s64 offen offset:1024 sc1
    v_mfma_f32_16x16x32_bf16 v[100:103], v[20:23], a[84:87], v[100:103]
    v_mfma_f32_16x16x32_bf16 v[104:107], v[20:23], a[148:151], v[104:107]
    ds_write_b128 v12, v[92:95] offset:19456
    v_mfma_f32_16x16x32_bf16 v[108:111], v[20:23], a[212:215], v[108:111]
    s_waitcnt vmcnt(11)
    v_mfma_f32_16x16x32_bf16 v[96:99], v[24:27], a[24:27], v[96:99]
    buffer_load_dwordx4 v[16:19], v4, s[4:7], s64 offen offset:2048 sc1
    v_mfma_f32_16x16x32_bf16 v[100:103], v[24:27], a[88:91], v[100:103]
    v_mfma_f32_16x16x32_bf16 v[104:107], v[24:27], a[152:155], v[104:107]
    v_mfma_f32_16x16x32_bf16 v[108:111], v[24:27], a[216:219], v[108:111]
    s_waitcnt vmcnt(11)
    s_waitcnt lgkmcnt(0)
    s_barrier
    v_mfma_f32_16x16x32_bf16 v[96:99], v[28:31], a[28:31], v[96:99]
    buffer_load_dwordx4 v[20:23], v4, s[4:7], s64 offen offset:3072 sc1
    ds_read_b128 v[144:147], v72 offset:0
    v_mfma_f32_16x16x32_bf16 v[100:103], v[28:31], a[92:95], v[100:103]
    ds_read_b128 v[148:151], v74 offset:0
    ds_read_b128 v[152:155], v76 offset:0
    v_mfma_f32_16x16x32_bf16 v[104:107], v[28:31], a[156:159], v[104:107]
    ds_read_b128 v[156:159], v72 offset:1024
    ds_read_b128 v[160:163], v74 offset:1024
    v_mfma_f32_16x16x32_bf16 v[108:111], v[28:31], a[220:223], v[108:111]
    ds_read_b128 v[164:167], v76 offset:1024
    s_waitcnt vmcnt(11)
    v_mfma_f32_16x16x32_bf16 v[96:99], v[32:35], a[32:35], v[96:99]
    s_add_u32 s64, s14, 4096
    buffer_load_dwordx4 v[24:27], v4, s[4:7], s64 offen offset:0 sc1
    v_mfma_f32_16x16x32_bf16 v[100:103], v[32:35], a[96:99], v[100:103]
    ds_read_b128 v[168:171], v72 offset:2048
    ds_read_b128 v[172:175], v74 offset:2048
    v_mfma_f32_16x16x32_bf16 v[104:107], v[32:35], a[160:163], v[104:107]
    ds_read_b128 v[176:179], v76 offset:2048
    ds_read_b128 v[180:183], v72 offset:3072
    v_mfma_f32_16x16x32_bf16 v[108:111], v[32:35], a[224:227], v[108:111]
    ds_read_b128 v[184:187], v74 offset:3072
    s_waitcnt vmcnt(11)
    v_mfma_f32_16x16x32_bf16 v[96:99], v[36:39], a[36:39], v[96:99]
    buffer_load_dwordx4 v[28:31], v4, s[4:7], s64 offen offset:1024 sc1
    ds_read_b128 v[188:191], v76 offset:3072
    v_mfma_f32_16x16x32_bf16 v[100:103], v[36:39], a[100:103], v[100:103]
    ds_read_b128 v[192:195], v75 offset:0
    ds_read_b128 v[196:199], v77 offset:0
    v_mfma_f32_16x16x32_bf16 v[104:107], v[36:39], a[164:167], v[104:107]
    ds_read_b128 v[200:203], v75 offset:1024
    ds_read_b128 v[204:207], v77 offset:1024
    v_mfma_f32_16x16x32_bf16 v[108:111], v[36:39], a[228:231], v[108:111]
    ds_read_b128 v[208:211], v75 offset:2048
    s_waitcnt vmcnt(11)
    v_mfma_f32_16x16x32_bf16 v[96:99], v[40:43], a[40:43], v[96:99]
    buffer_load_dwordx4 v[32:35], v4, s[4:7], s64 offen offset:2048 sc1
    ds_read_b128 v[212:215], v77 offset:2048
    v_mfma_f32_16x16x32_bf16 v[100:103], v[40:43], a[104:107], v[100:103]
    ds_read_b128 v[216:219], v75 offset:3072
    ds_read_b128 v[220:223], v77 offset:3072
    v_mfma_f32_16x16x32_bf16 v[104:107], v[40:43], a[168:171], v[104:107]
    s_waitcnt lgkmcnt(15)
    v_add_f32 v144, v144, v148
    v_mfma_f32_16x16x32_bf16 v[108:111], v[40:43], a[232:235], v[108:111]
    v_add_f32 v145, v145, v149
    s_waitcnt vmcnt(11)
    v_mfma_f32_16x16x32_bf16 v[96:99], v[44:47], a[44:47], v[96:99]
    buffer_load_dwordx4 v[36:39], v4, s[4:7], s64 offen offset:3072 sc1
    v_add_f32 v146, v146, v150
    v_mfma_f32_16x16x32_bf16 v[100:103], v[44:47], a[108:111], v[100:103]
    v_add_f32 v147, v147, v151
    v_add_f32 v144, v144, v152
    v_mfma_f32_16x16x32_bf16 v[104:107], v[44:47], a[172:175], v[104:107]
    v_add_f32 v145, v145, v153
    v_add_f32 v146, v146, v154
    v_mfma_f32_16x16x32_bf16 v[108:111], v[44:47], a[236:239], v[108:111]
    v_add_f32 v147, v147, v155
    s_waitcnt vmcnt(11)
    v_mfma_f32_16x16x32_bf16 v[96:99], v[48:51], a[48:51], v[96:99]
    s_add_u32 s64, s14, 8192
    buffer_load_dwordx4 v[40:43], v4, s[4:7], s64 offen offset:0 sc1
    v_mfma_f32_16x16x32_bf16 v[100:103], v[48:51], a[112:115], v[100:103]
    s_waitcnt lgkmcnt(14)
    v_add_f32 v156, v156, v160
    v_mfma_f32_16x16x32_bf16 v[104:107], v[48:51], a[176:179], v[104:107]
    v_add_f32 v157, v157, v161
    v_add_f32 v158, v158, v162
    v_mfma_f32_16x16x32_bf16 v[108:111], v[48:51], a[240:243], v[108:111]
    v_add_f32 v159, v159, v163
    s_waitcnt vmcnt(11)
    v_mfma_f32_16x16x32_bf16 v[96:99], v[52:55], a[52:55], v[96:99]
    buffer_load_dwordx4 v[44:47], v4, s[4:7], s64 offen offset:1024 sc1
    v_add_f32 v156, v156, v164
    v_mfma_f32_16x16x32_bf16 v[100:103], v[52:55], a[116:119], v[100:103]
    v_add_f32 v157, v157, v165
    v_add_f32 v158, v158, v166
    v_mfma_f32_16x16x32_bf16 v[104:107], v[52:55], a[180:183], v[104:107]
    v_add_f32 v159, v159, v167
    s_waitcnt lgkmcnt(11)
    v_mfma_f32_16x16x32_bf16 v[108:111], v[52:55], a[244:247], v[108:111]
    v_add_f32 v168, v168, v172
    s_waitcnt vmcnt(11)
    v_mfma_f32_16x16x32_bf16 v[96:99], v[56:59], a[56:59], v[96:99]
    buffer_load_dwordx4 v[48:51], v4, s[4:7], s64 offen offset:2048 sc1
    v_add_f32 v169, v169, v173
    v_mfma_f32_16x16x32_bf16 v[100:103], v[56:59], a[120:123], v[100:103]
    v_add_f32 v170, v170, v174
    v_add_f32 v171, v171, v175
    v_mfma_f32_16x16x32_bf16 v[104:107], v[56:59], a[184:187], v[104:107]
    v_add_f32 v168, v168, v176
    v_add_f32 v169, v169, v177
    v_mfma_f32_16x16x32_bf16 v[108:111], v[56:59], a[248:251], v[108:111]
    v_add_f32 v170, v170, v178
    s_waitcnt vmcnt(11)
    v_mfma_f32_16x16x32_bf16 v[96:99], v[60:63], a[60:63], v[96:99]
    buffer_load_dwordx4 v[52:55], v4, s[4:7], s64 offen offset:3072 sc1
    v_add_f32 v171, v171, v179
    v_mfma_f32_16x16x32_bf16 v[100:103], v[60:63], a[124:127], v[100:103]
    s_waitcnt lgkmcnt(8)
    v_add_f32 v180, v180, v184
    v_mfma_f32_16x16x32_bf16 v[104:107], v[60:63], a[188:191], v[104:107]
    v_add_f32 v181, v181, v185
    v_add_f32 v182, v182, v186
    v_mfma_f32_16x16x32_bf16 v[108:111], v[60:63], a[252:255], v[108:111]
    v_add_f32 v183, v183, v187
    s_waitcnt vmcnt(11)
    v_mfma_f32_16x16x32_bf16 v[80:83], v[64:67], a[0:3], v[224:227]
    s_add_u32 s64, s14, 12288
    buffer_load_dwordx4 v[56:59], v4, s[4:7], s64 offen offset:0 sc1
    v_mfma_f32_16x16x32_bf16 v[84:87], v[64:67], a[64:67], v[228:231]
    v_add_f32 v180, v180, v188
    v_add_f32 v181, v181, v189
    v_mfma_f32_16x16x32_bf16 v[88:91], v[64:67], a[128:131], v[232:235]
    ds_write_b128 v12, v[96:99] offset:20480
    v_add_f32 v182, v182, v190
    v_mfma_f32_16x16x32_bf16 v[92:95], v[64:67], a[192:195], v[236:239]
    ds_write_b128 v12, v[100:103] offset:21504
    s_waitcnt vmcnt(11)
    v_mfma_f32_16x16x32_bf16 v[80:83], v[68:71], a[4:7], v[80:83]
    buffer_load_dwordx4 v[60:63], v4, s[4:7], s64 offen offset:1024 sc1
    v_add_f32 v183, v183, v191
    v_mfma_f32_16x16x32_bf16 v[84:87], v[68:71], a[68:71], v[84:87]
    s_mov_b64 exec, 0xfffffff
    buffer_load_dword v7, v15, s[24:27], s96 offen
    s_mov_b64 exec, -1
    v_mfma_f32_16x16x32_bf16 v[88:91], v[68:71], a[132:135], v[88:91]
    ds_write_b128 v12, v[104:107] offset:22528
    v_mfma_f32_16x16x32_bf16 v[92:95], v[68:71], a[196:199], v[92:95]
    ds_write_b128 v12, v[108:111] offset:23552
    s_waitcnt vmcnt(12)
    s_waitcnt lgkmcnt(0)
    s_barrier
    v_mfma_f32_16x16x32_bf16 v[80:83], v[16:19], a[8:11], v[80:83]
    buffer_load_dwordx4 v[64:67], v4, s[4:7], s64 offen offset:2048 sc1
    ds_read_b128 v[148:151], v73 offset:0
    v_mfma_f32_16x16x32_bf16 v[84:87], v[16:19], a[72:75], v[84:87]
    ds_read_b128 v[160:163], v73 offset:1024
    ds_read_b128 v[172:175], v73 offset:2048
    v_mfma_f32_16x16x32_bf16 v[88:91], v[16:19], a[136:139], v[88:91]
    ds_read_b128 v[184:187], v73 offset:3072
    v_add_f32 v192, v192, v196
    v_mfma_f32_16x16x32_bf16 v[92:95], v[16:19], a[200:203], v[92:95]
    v_add_f32 v193, v193, v197
    s_waitcnt vmcnt(12)
    v_mfma_f32_16x16x32_bf16 v[80:83], v[20:23], a[12:15], v[80:83]
    buffer_load_dwordx4 v[68:71], v4, s[4:7], s64 offen offset:3072 sc1
    v_add_f32 v194, v194, v198
    v_mfma_f32_16x16x32_bf16 v[84:87], v[20:23], a[76:79], v[84:87]
    v_add_f32 v195, v195, v199
    v_add_f32 v200, v200, v204
    v_mfma_f32_16x16x32_bf16 v[88:91], v[20:23], a[140:143], v[88:91]
    v_add_f32 v201, v201, v205
    v_add_f32 v202, v202, v206
    v_mfma_f32_16x16x32_bf16 v[92:95], v[20:23], a[204:207], v[92:95]
    v_add_f32 v203, v203, v207
    s_waitcnt vmcnt(12)
    v_mfma_f32_16x16x32_bf16 v[80:83], v[24:27], a[16:19], v[80:83]
    s_add_u32 m0, s17, 0
    s_add_u32 s64, s16, 0
    v_mfma_f32_16x16x32_bf16 v[84:87], v[24:27], a[80:83], v[84:87]
    buffer_load_dwordx4 v13, s[24:27], s64 offen lds
    v_add_f32 v208, v208, v212
    v_mfma_f32_16x16x32_bf16 v[88:91], v[24:27], a[144:147], v[88:91]
    v_add_f32 v209, v209, v213
    v_add_f32 v210, v210, v214
    v_mfma_f32_16x16x32_bf16 v[92:95], v[24:27], a[208:211], v[92:95]
    v_add_f32 v211, v211, v215
    s_waitcnt vmcnt(12)
    v_mfma_f32_16x16x32_bf16 v[80:83], v[28:31], a[20:23], v[80:83]
    s_add_u32 m0, s17, 1024
    s_add_u32 s64, s16, 8192
    v_mfma_f32_16x16x32_bf16 v[84:87], v[28:31], a[84:87], v[84:87]
    buffer_load_dwordx4 v13, s[24:27], s64 offen lds
    v_add_f32 v216, v216, v220
    v_mfma_f32_16x16x32_bf16 v[88:91], v[28:31], a[148:151], v[88:91]
    v_add_f32 v217, v217, v221
    v_add_f32 v218, v218, v222
    v_mfma_f32_16x16x32_bf16 v[92:95], v[28:31], a[212:215], v[92:95]
    v_add_f32 v219, v219, v223
    s_waitcnt vmcnt(12)
    v_mfma_f32_16x16x32_bf16 v[80:83], v[32:35], a[24:27], v[80:83]
    s_add_u32 m0, s17, 2048
    s_add_u32 s64, s16, 16384
    v_mfma_f32_16x16x32_bf16 v[84:87], v[32:35], a[88:91], v[84:87]
    buffer_load_dwordx4 v13, s[24:27], s64 offen lds
    v_add_f32 v96, v96, v144
    v_mfma_f32_16x16x32_bf16 v[88:91], v[32:35], a[152:155], v[88:91]
    v_add_f32 v97, v97, v145
    v_add_f32 v98, v98, v146
    v_mfma_f32_16x16x32_bf16 v[92:95], v[32:35], a[216:219], v[92:95]
    v_add_f32 v99, v99, v147
    s_waitcnt vmcnt(12)
    v_mfma_f32_16x16x32_bf16 v[80:83], v[36:39], a[28:31], v[80:83]
    s_add_u32 m0, s17, 3072
    s_add_u32 s64, s16, 24576
    v_mfma_f32_16x16x32_bf16 v[84:87], v[36:39], a[92:95], v[84:87]
    buffer_load_dwordx4 v13, s[24:27], s64 offen lds
    v_mul_f32 v96, v96, v112
    v_mfma_f32_16x16x32_bf16 v[88:91], v[36:39], a[156:159], v[88:91]
    v_mul_f32 v97, v97, v113
    v_mul_f32 v98, v98, v114
    v_mfma_f32_16x16x32_bf16 v[92:95], v[36:39], a[220:223], v[92:95]
    v_mul_f32 v99, v99, v115
    s_waitcnt vmcnt(12)
    v_mfma_f32_16x16x32_bf16 v[80:83], v[40:43], a[32:35], v[80:83]
    s_add_u32 m0, s17, 4096
    s_add_u32 s64, s16, 32768
    v_mfma_f32_16x16x32_bf16 v[84:87], v[40:43], a[96:99], v[84:87]
    buffer_load_dwordx4 v13, s[24:27], s64 offen lds
    v_cvt_pk_bf16_f32 v144, v96, v97
    v_mfma_f32_16x16x32_bf16 v[88:91], v[40:43], a[160:163], v[88:91]
    v_cvt_pk_bf16_f32 v145, v98, v99
    v_add_f32 v100, v100, v156
    v_mfma_f32_16x16x32_bf16 v[92:95], v[40:43], a[224:227], v[92:95]
    v_add_f32 v101, v101, v157
    s_waitcnt vmcnt(12)
    v_mfma_f32_16x16x32_bf16 v[80:83], v[44:47], a[36:39], v[80:83]
    s_add_u32 m0, s17, 5120
    s_add_u32 s64, s16, 40960
    v_mfma_f32_16x16x32_bf16 v[84:87], v[44:47], a[100:103], v[84:87]
    buffer_load_dwordx4 v13, s[24:27], s64 offen lds
    v_add_f32 v102, v102, v158
    v_mfma_f32_16x16x32_bf16 v[88:91], v[44:47], a[164:167], v[88:91]
    v_add_f32 v103, v103, v159
    v_mul_f32 v100, v100, v120
    v_mfma_f32_16x16x32_bf16 v[92:95], v[44:47], a[228:231], v[92:95]
    v_mul_f32 v101, v101, v121
    s_waitcnt vmcnt(12)
    v_mfma_f32_16x16x32_bf16 v[80:83], v[48:51], a[40:43], v[80:83]
    s_add_u32 m0, s17, 6144
    s_add_u32 s64, s16, 49152
    v_mfma_f32_16x16x32_bf16 v[84:87], v[48:51], a[104:107], v[84:87]
    buffer_load_dwordx4 v13, s[24:27], s64 offen lds
    v_mul_f32 v102, v102, v122
    v_mfma_f32_16x16x32_bf16 v[88:91], v[48:51], a[168:171], v[88:91]
    v_mul_f32 v103, v103, v123
    v_cvt_pk_bf16_f32 v156, v100, v101
    v_mfma_f32_16x16x32_bf16 v[92:95], v[48:51], a[232:235], v[92:95]
    v_cvt_pk_bf16_f32 v157, v102, v103
    s_waitcnt vmcnt(12)
    v_mfma_f32_16x16x32_bf16 v[80:83], v[52:55], a[44:47], v[80:83]
    s_add_u32 m0, s17, 7168
    s_add_u32 s64, s16, 57344
    v_mfma_f32_16x16x32_bf16 v[84:87], v[52:55], a[108:111], v[84:87]
    buffer_load_dwordx4 v13, s[24:27], s64 offen lds
    v_add_f32 v104, v104, v168
    v_mfma_f32_16x16x32_bf16 v[88:91], v[52:55], a[172:175], v[88:91]
    v_add_f32 v105, v105, v169
    v_add_f32 v106, v106, v170
    v_mfma_f32_16x16x32_bf16 v[92:95], v[52:55], a[236:239], v[92:95]
    v_add_f32 v107, v107, v171
    s_waitcnt vmcnt(12)
    v_mfma_f32_16x16x32_bf16 v[80:83], v[56:59], a[48:51], v[80:83]
    s_add_u32 m0, s17, 8192
    s_add_u32 s64, s16, 65536
    v_mfma_f32_16x16x32_bf16 v[84:87], v[56:59], a[112:115], v[84:87]
    buffer_load_dwordx4 v13, s[24:27], s64 offen lds
    v_mul_f32 v104, v104, v128
    v_mfma_f32_16x16x32_bf16 v[88:91], v[56:59], a[176:179], v[88:91]
    v_mul_f32 v105, v105, v129
    v_mul_f32 v106, v106, v130
    v_mfma_f32_16x16x32_bf16 v[92:95], v[56:59], a[240:243], v[92:95]
    v_mul_f32_e64 v107, v107, v131
    s_waitcnt vmcnt(12)
    v_mfma_f32_16x16x32_bf16 v[80:83], v[60:63], a[52:55], v[80:83]
    s_add_u32 m0, s17, 9216
    s_add_u32 s64, s16, 73728
    v_mfma_f32_16x16x32_bf16 v[84:87], v[60:63], a[116:119], v[84:87]
    buffer_load_dwordx4 v13, s[24:27], s64 offen lds
    v_cvt_pk_bf16_f32 v168, v104, v105
    v_mfma_f32_16x16x32_bf16 v[88:91], v[60:63], a[180:183], v[88:91]
    v_cvt_pk_bf16_f32 v169, v106, v107
    v_add_f32 v108, v108, v180
    v_mfma_f32_16x16x32_bf16 v[92:95], v[60:63], a[244:247], v[92:95]
    v_add_f32 v109, v109, v181
    s_waitcnt vmcnt(11)
    v_mfma_f32_16x16x32_bf16 v[80:83], v[64:67], a[56:59], v[80:83]
    s_add_u32 m0, s17, 10240
    s_add_u32 s64, s16, 81920
    v_mfma_f32_16x16x32_bf16 v[84:87], v[64:67], a[120:123], v[84:87]
    buffer_load_dwordx4 v13, s[24:27], s64 offen lds
    v_add_f32 v110, v110, v182
    v_mfma_f32_16x16x32_bf16 v[88:91], v[64:67], a[184:187], v[88:91]
    v_add_f32 v111, v111, v183
    v_mul_f32 v108, v108, v136
    v_mfma_f32_16x16x32_bf16 v[92:95], v[64:67], a[248:251], v[92:95]
    v_mul_f32 v109, v109, v137
    s_waitcnt vmcnt(11)
    v_mfma_f32_16x16x32_bf16 v[80:83], v[68:71], a[60:63], v[80:83]
    s_add_u32 m0, s17, 11264
    s_add_u32 s64, s16, 90112
    v_mfma_f32_16x16x32_bf16 v[84:87], v[68:71], a[124:127], v[84:87]
    buffer_load_dwordx4 v13, s[24:27], s64 offen lds
    v_mul_f32 v110, v110, v138
    v_mfma_f32_16x16x32_bf16 v[88:91], v[68:71], a[188:191], v[88:91]
    v_mul_f32 v111, v111, v139
    v_cvt_pk_bf16_f32 v180, v108, v109
    v_mfma_f32_16x16x32_bf16 v[92:95], v[68:71], a[252:255], v[92:95]
    v_cvt_pk_bf16_f32 v181, v110, v111
    s_waitcnt lgkmcnt(0)
    v_add_f32 v192, v192, v148
    v_add_f32 v193, v193, v149
    v_add_f32 v194, v194, v150
    v_add_f32 v195, v195, v151
    v_add_f32 v200, v200, v160
    v_add_f32 v201, v201, v161
    v_add_f32 v202, v202, v162
    v_add_f32 v203, v203, v163
    v_add_f32 v208, v208, v172
    v_add_f32 v209, v209, v173
    v_add_f32 v210, v210, v174
    v_add_f32 v211, v211, v175
    v_add_f32 v216, v216, v184
    v_add_f32 v217, v217, v185
    v_add_f32 v218, v218, v186
    v_add_f32_e64 v219, v219, v187
    v_pk_add_f32 v[80:81], v[80:81], v[192:193]
    v_pk_add_f32 v[82:83], v[82:83], v[194:195]
    v_pk_mul_f32 v[80:81], v[80:81], v[116:117]
    v_pk_mul_f32 v[82:83], v[82:83], v[118:119]
    v_cvt_pk_bf16_f32 v146, v80, v81
    v_cvt_pk_bf16_f32 v147, v82, v83
    v_pk_add_f32 v[84:85], v[84:85], v[200:201]
    v_pk_add_f32 v[86:87], v[86:87], v[202:203]
    v_pk_mul_f32 v[84:85], v[84:85], v[124:125]
    v_pk_mul_f32 v[86:87], v[86:87], v[126:127]
    v_cvt_pk_bf16_f32 v158, v84, v85
    v_cvt_pk_bf16_f32 v159, v86, v87
    v_pk_add_f32 v[88:89], v[88:89], v[208:209]
    v_pk_add_f32 v[90:91], v[90:91], v[210:211]
    v_pk_mul_f32 v[88:89], v[88:89], v[132:133]
    v_pk_mul_f32 v[90:91], v[90:91], v[134:135]
    v_cvt_pk_bf16_f32 v170, v88, v89
    v_cvt_pk_bf16_f32 v171, v90, v91
    v_pk_add_f32 v[92:93], v[92:93], v[216:217]
    v_pk_add_f32 v[94:95], v[94:95], v[218:219]
    v_pk_mul_f32 v[92:93], v[92:93], v[140:141]
    v_pk_mul_f32 v[94:95], v[94:95], v[142:143]
    v_cvt_pk_bf16_f32 v182, v92, v93
    v_cvt_pk_bf16_f32 v183, v94, v95
    s_cmp_eq_u32 s50, 3
    s_cbranch_scc1 L_33
    buffer_store_dwordx4 v[144:147], v4, s[4:7], s46 offen sc1
    buffer_store_dwordx4 v[156:159], v4, s[4:7], s47 offen sc1
    buffer_store_dwordx4 v[168:171], v4, s[4:7], s0 offen sc1
    buffer_store_dwordx4 v[180:183], v4, s[4:7], s1 offen sc1
    s_branch L_34
L_33:
    buffer_store_dwordx2 v[146:147], v14, s[4:7], s46 offen sc1
    buffer_store_dwordx2 v[158:159], v14, s[4:7], s47 offen sc1
    buffer_store_dwordx2 v[170:171], v14, s[4:7], s0 offen sc1
    buffer_store_dwordx2 v[182:183], v14, s[4:7], s1 offen sc1
L_34:
    s_add_u32 m0, s17, 12288
    s_add_u32 s64, s16, 98304
    buffer_load_dwordx4 v13, s[24:27], s64 offen lds
    s_add_u32 m0, s17, 13312
    s_add_u32 s64, s16, 106496
    buffer_load_dwordx4 v13, s[24:27], s64 offen lds
    v_lshrrev_b32 v5, 2, v2
    v_lshl_add_u32 v5, v3, 2, v5
    v_bfe_u32 v6, v5, 1, 2
    v_lshlrev_b32 v5, 7, v5
    v_and_b32 v7, 3, v2
    v_lshl_add_u32 v5, v7, 3, v5
    v_xor_b32_e64 v7, 0, v6
    v_lshl_add_u32 v16, v7, 5, v5
    v_add_u32 v20, 0x10000, v16
    v_xor_b32_e64 v7, 1, v6
    v_lshl_add_u32 v17, v7, 5, v5
    v_add_u32 v21, 0x10000, v17
    v_xor_b32_e64 v7, 2, v6
    v_lshl_add_u32 v18, v7, 5, v5
    v_add_u32 v22, 0x10000, v18
    v_xor_b32_e64 v7, 3, v6
    v_lshl_add_u32 v19, v7, 5, v5
    v_add_u32 v23, 0x10000, v19
    s_add_u32 m0, s17, 14336
    s_add_u32 s64, s16, 114688
    buffer_load_dwordx4 v13, s[24:27], s64 offen lds
    s_waitcnt vmcnt(11) lgkmcnt(0)
    s_barrier
    ds_read_b64_tr_b16 a[0:1], v16 offset:0
    ds_read_b64_tr_b16 a[2:3], v16 offset:2048
    ds_read_b64_tr_b16 a[4:5], v17 offset:0
    ds_read_b64_tr_b16 a[6:7], v17 offset:2048
    ds_read_b64_tr_b16 a[8:9], v18 offset:0
    ds_read_b64_tr_b16 a[10:11], v18 offset:2048
    ds_read_b64_tr_b16 a[12:13], v19 offset:0
    ds_read_b64_tr_b16 a[14:15], v19 offset:2048
    ds_read_b64_tr_b16 a[16:17], v16 offset:4096
    ds_read_b64_tr_b16 a[18:19], v16 offset:6144
    ds_read_b64_tr_b16 a[20:21], v17 offset:4096
    ds_read_b64_tr_b16 a[22:23], v17 offset:6144
    ds_read_b64_tr_b16 a[24:25], v18 offset:4096
    ds_read_b64_tr_b16 a[26:27], v18 offset:6144
    ds_read_b64_tr_b16 a[28:29], v19 offset:4096
    ds_read_b64_tr_b16 a[30:31], v19 offset:6144
    s_add_u32 m0, s17, 15360
    s_add_u32 s64, s16, 122880
    buffer_load_dwordx4 v13, s[24:27], s64 offen lds
    ds_read_b64_tr_b16 a[64:65], v16 offset:16384
    ds_read_b64_tr_b16 a[66:67], v16 offset:18432
    ds_read_b64_tr_b16 a[68:69], v17 offset:16384
    ds_read_b64_tr_b16 a[70:71], v17 offset:18432
    ds_read_b64_tr_b16 a[72:73], v18 offset:16384
    ds_read_b64_tr_b16 a[74:75], v18 offset:18432
    ds_read_b64_tr_b16 a[76:77], v19 offset:16384
    ds_read_b64_tr_b16 a[78:79], v19 offset:18432
    ds_read_b64_tr_b16 a[80:81], v16 offset:20480
    ds_read_b64_tr_b16 a[82:83], v16 offset:22528
    ds_read_b64_tr_b16 a[84:85], v17 offset:20480
    ds_read_b64_tr_b16 a[86:87], v17 offset:22528
    ds_read_b64_tr_b16 a[88:89], v18 offset:20480
    ds_read_b64_tr_b16 a[90:91], v18 offset:22528
    ds_read_b64_tr_b16 a[92:93], v19 offset:20480
    ds_read_b64_tr_b16 a[94:95], v19 offset:22528
    s_add_u32 m0, s71, 0
    s_add_u32 s64, s70, 0
    buffer_load_dwordx4 v13, s[24:27], s64 offen lds
    ds_read_b64_tr_b16 a[128:129], v16 offset:32768
    ds_read_b64_tr_b16 a[130:131], v16 offset:34816
    ds_read_b64_tr_b16 a[132:133], v17 offset:32768
    ds_read_b64_tr_b16 a[134:135], v17 offset:34816
    ds_read_b64_tr_b16 a[136:137], v18 offset:32768
    ds_read_b64_tr_b16 a[138:139], v18 offset:34816
    ds_read_b64_tr_b16 a[140:141], v19 offset:32768
    ds_read_b64_tr_b16 a[142:143], v19 offset:34816
    ds_read_b64_tr_b16 a[144:145], v16 offset:36864
    ds_read_b64_tr_b16 a[146:147], v16 offset:38912
    ds_read_b64_tr_b16 a[148:149], v17 offset:36864
    ds_read_b64_tr_b16 a[150:151], v17 offset:38912
    ds_read_b64_tr_b16 a[152:153], v18 offset:36864
    ds_read_b64_tr_b16 a[154:155], v18 offset:38912
    ds_read_b64_tr_b16 a[156:157], v19 offset:36864
    ds_read_b64_tr_b16 a[158:159], v19 offset:38912
    s_add_u32 m0, s71, 1024
    s_add_u32 s64, s70, 8192
    buffer_load_dwordx4 v13, s[24:27], s64 offen lds
    ds_read_b64_tr_b16 a[192:193], v16 offset:49152
    ds_read_b64_tr_b16 a[194:195], v16 offset:51200
    ds_read_b64_tr_b16 a[196:197], v17 offset:49152
    ds_read_b64_tr_b16 a[198:199], v17 offset:51200
    ds_read_b64_tr_b16 a[200:201], v18 offset:49152
    ds_read_b64_tr_b16 a[202:203], v18 offset:51200
    ds_read_b64_tr_b16 a[204:205], v19 offset:49152
    ds_read_b64_tr_b16 a[206:207], v19 offset:51200
    ds_read_b64_tr_b16 a[208:209], v16 offset:53248
    ds_read_b64_tr_b16 a[210:211], v16 offset:55296
    ds_read_b64_tr_b16 a[212:213], v17 offset:53248
    ds_read_b64_tr_b16 a[214:215], v17 offset:55296
    ds_read_b64_tr_b16 a[216:217], v18 offset:53248
    ds_read_b64_tr_b16 a[218:219], v18 offset:55296
    ds_read_b64_tr_b16 a[220:221], v19 offset:53248
    ds_read_b64_tr_b16 a[222:223], v19 offset:55296
    s_add_u32 m0, s71, 2048
    s_add_u32 s64, s70, 16384
    buffer_load_dwordx4 v13, s[24:27], s64 offen lds
    v_mul_u32_u24 v5, 37, v1
    v_lshrrev_b32 v5, 8, v5
    v_mul_u32_u24 v6, 7, v5
    v_sub_u32 v6, v1, v6
    v_cmp_eq_u32 s[56:57], 3, v6
    v_cmp_le_u32 vcc, 28, v1
    v_lshl_add_u32 v6, v6, 1, 1
    v_lshlrev_b32 v5, 1, v5
    v_cndmask_b32 v5, v5, v6, vcc
    s_or_b64 vcc, vcc, s[56:57]
    v_lshl_add_u32 v5, v5, 9, s89
    v_add_u32 v5, 508, v5
    v_lshl_add_u32 v6, v1, 10, s88
    v_add_u32 v6, 1020, v6
    v_cndmask_b32 v6, v6, v5, vcc
    v_lshlrev_b32 v5, 10, v2
    s_add_u32 m0, s71, 3072
    s_add_u32 s64, s70, 24576
    buffer_load_dwordx4 v13, s[24:27], s64 offen lds
    v_and_b32 v7, 1, v3
    v_mul_u32_u24 v7, 24, v7
    v_lshl_add_u32 v7, v3, 3, v7
    v_add_u32 v5, v5, v7
    v_lshlrev_b32 v7, 3, v1
    s_add_u32 m0, s71, 4096
    s_add_u32 s64, s70, 32768
    buffer_load_dwordx4 v13, s[24:27], s64 offen lds
    s_add_u32 m0, s71, 5120
    s_add_u32 s64, s70, 40960
    buffer_load_dwordx4 v13, s[24:27], s64 offen lds
    s_add_u32 m0, s71, 6144
    s_add_u32 s64, s70, 49152
    buffer_load_dwordx4 v13, s[24:27], s64 offen lds
    s_add_u32 m0, s71, 7168
    s_add_u32 s64, s70, 57344
    buffer_load_dwordx4 v13, s[24:27], s64 offen lds
    s_mov_b32 exec_hi, 0
    buffer_load_dword v8, v6, s[4:7], 0 offen sc1
    s_mov_b32 exec_hi, -1
    s_add_u32 m0, s71, 8192
    s_add_u32 s64, s70, 65536
    buffer_load_dwordx4 v13, s[24:27], s64 offen lds
    s_add_u32 m0, s71, 9216
    s_add_u32 s64, s70, 73728
    buffer_load_dwordx4 v13, s[24:27], s64 offen lds
    s_add_u32 m0, s71, 10240
    s_add_u32 s64, s70, 81920
    buffer_load_dwordx4 v13, s[24:27], s64 offen lds
    s_add_u32 m0, s71, 11264
    s_add_u32 s64, s70, 90112
    buffer_load_dwordx4 v13, s[24:27], s64 offen lds
    s_mov_b32 exec_hi, 0
    s_mov_b32 s54, 0
    s_waitcnt vmcnt(4)
    s_branch can_35c
can_35:
    buffer_load_dword v8, v6, s[4:7], 0 offen sc1
    s_add_u32 s54, s54, 1
    s_waitcnt vmcnt(0)
can_35c:
    v_cmp_eq_u32 vcc, -1, v8
    s_cbranch_vccz canx_36
    s_cmp_lt_u32 s54, 0x40000
    s_cbranch_scc1 can_35
canx_36:
    s_mov_b32 exec_hi, -1
    s_mov_b32 s54, 0
    s_add_u32 s64, s88, 0
    buffer_load_dwordx4 v[168:171], v4, s[4:7], s64 offen offset:0 sc1
    buffer_load_dwordx4 v[172:175], v4, s[4:7], s64 offen offset:1024 sc1
    s_add_u32 s64, s88, 4096
    buffer_load_dwordx4 v[176:179], v4, s[4:7], s64 offen offset:0 sc1
    buffer_load_dwordx4 v[180:183], v4, s[4:7], s64 offen offset:1024 sc1
    s_add_u32 s64, s88, 8192
    buffer_load_dwordx4 v[184:187], v4, s[4:7], s64 offen offset:0 sc1
    buffer_load_dwordx4 v[188:191], v4, s[4:7], s64 offen offset:1024 sc1
    s_add_u32 s64, s88, 12288
    buffer_load_dwordx4 v[192:195], v4, s[4:7], s64 offen offset:0 sc1
    buffer_load_dwordx4 v[196:199], v4, s[4:7], s64 offen offset:1024 sc1
    v_and_b32_e64 v6, 8, v2
    v_mul_u32_u24 v6, 1016, v6
    v_sub_u32_e64 v5, v5, v6
    v_add_u32 v6, 0x2000, v5
    s_waitcnt vmcnt(8)
    s_barrier
L_p5:
    ds_read_b64_tr_b16 a[32:33], v16 offset:8192
    ds_read_b64_tr_b16 a[34:35], v16 offset:10240
    ds_read_b64_tr_b16 a[36:37], v17 offset:8192
    ds_read_b64_tr_b16 a[38:39], v17 offset:10240
    ds_read_b64_tr_b16 a[40:41], v18 offset:8192
    ds_read_b64_tr_b16 a[42:43], v18 offset:10240
    ds_read_b64_tr_b16 a[44:45], v19 offset:8192
    ds_read_b64_tr_b16 a[46:47], v19 offset:10240
    ds_read_b64_tr_b16 a[48:49], v16 offset:12288
    ds_read_b64_tr_b16 a[50:51], v16 offset:14336
    ds_read_b64_tr_b16 a[52:53], v17 offset:12288
    ds_read_b64_tr_b16 a[54:55], v17 offset:14336
    ds_read_b64_tr_b16 a[56:57], v18 offset:12288
    ds_read_b64_tr_b16 a[58:59], v18 offset:14336
    ds_read_b64_tr_b16 a[60:61], v19 offset:12288
    ds_read_b64_tr_b16 a[62:63], v19 offset:14336
    ds_read_b64_tr_b16 a[96:97], v16 offset:24576
    ds_read_b64_tr_b16 a[98:99], v16 offset:26624
    ds_read_b64_tr_b16 a[100:101], v17 offset:24576
    ds_read_b64_tr_b16 a[102:103], v17 offset:26624
    ds_read_b64_tr_b16 a[104:105], v18 offset:24576
    ds_read_b64_tr_b16 a[106:107], v18 offset:26624
    ds_read_b64_tr_b16 a[108:109], v19 offset:24576
    ds_read_b64_tr_b16 a[110:111], v19 offset:26624
    s_waitcnt lgkmcnt(15)
    s_waitcnt vmcnt(7)
    v_mfma_f32_16x16x32_bf16 v[8:11], a[0:3], v[168:171], 0
    s_add_u32 s64, s88, 0
    buffer_load_dwordx4 v[200:203], v4, s[4:7], s64 offen offset:2048 sc1
    v_mfma_f32_16x16x32_bf16 v[12:15], a[4:7], v[168:171], 0
    ds_read_b64_tr_b16 a[112:113], v16 offset:28672
    ds_read_b64_tr_b16 a[114:115], v16 offset:30720
    v_mfma_f32_16x16x32_bf16 v[216:219], a[8:11], v[168:171], 0
    ds_read_b64_tr_b16 a[116:117], v17 offset:28672
    ds_read_b64_tr_b16 a[118:119], v17 offset:30720
    v_mfma_f32_16x16x32_bf16 v[220:223], a[12:15], v[168:171], 0
    ds_read_b64_tr_b16 a[120:121], v18 offset:28672
    s_waitcnt vmcnt(7)
    v_mfma_f32_16x16x32_bf16 v[8:11], a[16:19], v[172:175], v[8:11]
    buffer_load_dwordx2 v[204:205], v7, s[4:7], s89 offen offset:0 sc1
    buffer_load_dwordx2 v[206:207], v7, s[4:7], s89 offen offset:512 sc1
    v_mfma_f32_16x16x32_bf16 v[12:15], a[20:23], v[172:175], v[12:15]
    ds_read_b64_tr_b16 a[122:123], v18 offset:30720
    ds_read_b64_tr_b16 a[124:125], v19 offset:28672
    v_mfma_f32_16x16x32_bf16 v[216:219], a[24:27], v[172:175], v[216:219]
    ds_read_b64_tr_b16 a[126:127], v19 offset:30720
    ds_read_b64_tr_b16 a[160:161], v16 offset:40960
    v_mfma_f32_16x16x32_bf16 v[220:223], a[28:31], v[172:175], v[220:223]
    ds_read_b64_tr_b16 a[162:163], v16 offset:43008
    s_waitcnt vmcnt(8)
    v_mfma_f32_16x16x32_bf16 v[8:11], a[64:67], v[176:179], v[8:11]
    s_add_u32 s64, s88, 4096
    buffer_load_dwordx4 v[208:211], v4, s[4:7], s64 offen offset:2048 sc1
    v_mfma_f32_16x16x32_bf16 v[12:15], a[68:71], v[176:179], v[12:15]
    ds_read_b64_tr_b16 a[164:165], v17 offset:40960
    ds_read_b64_tr_b16 a[166:167], v17 offset:43008
    v_mfma_f32_16x16x32_bf16 v[216:219], a[72:75], v[176:179], v[216:219]
    ds_read_b64_tr_b16 a[168:169], v18 offset:40960
    ds_read_b64_tr_b16 a[170:171], v18 offset:43008
    v_mfma_f32_16x16x32_bf16 v[220:223], a[76:79], v[176:179], v[220:223]
    ds_read_b64_tr_b16 a[172:173], v19 offset:40960
    s_waitcnt vmcnt(8)
    v_mfma_f32_16x16x32_bf16 v[8:11], a[80:83], v[180:183], v[8:11]
    buffer_load_dwordx4 v[212:215], v4, s[4:7], s64 offen offset:3072 sc1
    ds_read_b64_tr_b16 a[174:175], v19 offset:43008
    v_mfma_f32_16x16x32_bf16 v[12:15], a[84:87], v[180:183], v[12:15]
    ds_read_b64_tr_b16 a[176:177], v16 offset:45056
    ds_read_b64_tr_b16 a[178:179], v16 offset:47104
    v_mfma_f32_16x16x32_bf16 v[216:219], a[88:91], v[180:183], v[216:219]
    ds_read_b64_tr_b16 a[180:181], v17 offset:45056
    ds_read_b64_tr_b16 a[182:183], v17 offset:47104
    v_mfma_f32_16x16x32_bf16 v[220:223], a[92:95], v[180:183], v[220:223]
    ds_read_b64_tr_b16 a[184:185], v18 offset:45056
    s_waitcnt vmcnt(8)
    v_mfma_f32_16x16x32_bf16 v[8:11], a[128:131], v[184:187], v[8:11]
    buffer_load_dwordx2 v[168:169], v7, s[4:7], s89 offen offset:1024 sc1
    buffer_load_dwordx2 v[170:171], v7, s[4:7], s89 offen offset:1536 sc1
    v_mfma_f32_16x16x32_bf16 v[12:15], a[132:135], v[184:187], v[12:15]
    ds_read_b64_tr_b16 a[186:187], v18 offset:47104
    ds_read_b64_tr_b16 a[188:189], v19 offset:45056
    v_mfma_f32_16x16x32_bf16 v[216:219], a[136:139], v[184:187], v[216:219]
    ds_read_b64_tr_b16 a[190:191], v19 offset:47104
    ds_read_b64_tr_b16 a[224:225], v16 offset:57344
    v_mfma_f32_16x16x32_bf16 v[220:223], a[140:143], v[184:187], v[220:223]
    ds_read_b64_tr_b16 a[226:227], v16 offset:59392
    s_waitcnt vmcnt(9)
    v_mfma_f32_16x16x32_bf16 v[8:11], a[144:147], v[188:191], v[8:11]
    s_add_u32 s64, s88, 8192
    buffer_load_dwordx4 v[172:175], v4, s[4:7], s64 offen offset:3072 sc1
    v_mfma_f32_16x16x32_bf16 v[12:15], a[148:151], v[188:191], v[12:15]
    ds_read_b64_tr_b16 a[228:229], v17 offset:57344
    ds_read_b64_tr_b16 a[230:231], v17 offset:59392
    v_mfma_f32_16x16x32_bf16 v[216:219], a[152:155], v[188:191], v[216:219]
    ds_read_b64_tr_b16 a[232:233], v18 offset:57344
    ds_read_b64_tr_b16 a[234:235], v18 offset:59392
    v_mfma_f32_16x16x32_bf16 v[220:223], a[156:159], v[188:191], v[220:223]
    ds_read_b64_tr_b16 a[236:237], v19 offset:57344
    s_waitcnt vmcnt(9)
    v_mfma_f32_16x16x32_bf16 v[8:11], a[192:195], v[192:195], v[8:11]
    s_add_u32 s64, s88, 12288
    buffer_load_dwordx4 v[176:179], v4, s[4:7], s64 offen offset:2048 sc1
    v_mfma_f32_16x16x32_bf16 v[12:15], a[196:199], v[192:195], v[12:15]
    ds_read_b64_tr_b16 a[238:239], v19 offset:59392
    ds_read_b64_tr_b16 a[240:241], v16 offset:61440
    v_mfma_f32_16x16x32_bf16 v[216:219], a[200:203], v[192:195], v[216:219]
    ds_read_b64_tr_b16 a[242:243], v16 offset:63488
    ds_read_b64_tr_b16 a[244:245], v17 offset:61440
    v_mfma_f32_16x16x32_bf16 v[220:223], a[204:207], v[192:195], v[220:223]
    ds_read_b64_tr_b16 a[246:247], v17 offset:63488
    s_waitcnt vmcnt(9)
    v_mfma_f32_16x16x32_bf16 v[8:11], a[208:211], v[196:199], v[8:11]
    buffer_load_dwordx4 v[180:183], v4, s[4:7], s64 offen offset:3072 sc1
    ds_read_b64_tr_b16 a[248:249], v18 offset:61440
    v_mfma_f32_16x16x32_bf16 v[12:15], a[212:215], v[196:199], v[12:15]
    ds_read_b64_tr_b16 a[250:251], v18 offset:63488
    ds_read_b64_tr_b16 a[252:253], v19 offset:61440
    v_mfma_f32_16x16x32_bf16 v[216:219], a[216:219], v[196:199], v[216:219]
    ds_read_b64_tr_b16 a[254:255], v19 offset:63488
    ds_read_b64_tr_b16 v[24:25], v20 offset:0
    v_mfma_f32_16x16x32_bf16 v[220:223], a[220:223], v[196:199], v[220:223]
    ds_read_b64_tr_b16 v[26:27], v20 offset:2048
    s_waitcnt vmcnt(9)
    s_waitcnt lgkmcnt(15)
    v_mfma_f32_16x16x32_bf16 v[8:11], a[32:35], v[200:203], v[8:11]
    s_add_u32 s64, s88, 16384
    buffer_load_dwordx4 v[184:187], v4, s[4:7], s64 offen offset:0 sc1
    v_mfma_f32_16x16x32_bf16 v[12:15], a[36:39], v[200:203], v[12:15]
    ds_read_b64_tr_b16 v[28:29], v21 offset:0
    ds_read_b64_tr_b16 v[30:31], v21 offset:2048
    v_mfma_f32_16x16x32_bf16 v[216:219], a[40:43], v[200:203], v[216:219]
    ds_read_b64_tr_b16 v[32:33], v22 offset:0
    ds_read_b64_tr_b16 v[34:35], v22 offset:2048
    v_mfma_f32_16x16x32_bf16 v[220:223], a[44:47], v[200:203], v[220:223]
    ds_read_b64_tr_b16 v[36:37], v23 offset:0
    s_waitcnt vmcnt(8)
    s_waitcnt lgkmcnt(15)
    v_mfma_f32_16x16x32_bf16 v[8:11], a[48:51], v[204:207], v[8:11]
    buffer_load_dwordx2 v[188:189], v7, s[4:7], s89 offen offset:2048 sc1
    buffer_load_dwordx2 v[190:191], v7, s[4:7], s89 offen offset:2560 sc1
    v_mfma_f32_16x16x32_bf16 v[12:15], a[52:55], v[204:207], v[12:15]
    ds_read_b64_tr_b16 v[38:39], v23 offset:2048
    ds_read_b64_tr_b16 v[40:41], v20 offset:4096
    v_mfma_f32_16x16x32_bf16 v[216:219], a[56:59], v[204:207], v[216:219]
    ds_read_b64_tr_b16 v[42:43], v20 offset:6144
    ds_read_b64_tr_b16 v[44:45], v21 offset:4096
    v_mfma_f32_16x16x32_bf16 v[220:223], a[60:63], v[204:207], v[220:223]
    ds_read_b64_tr_b16 v[46:47], v21 offset:6144
    s_waitcnt vmcnt(9)
    s_waitcnt lgkmcnt(15)
    v_mfma_f32_16x16x32_bf16 v[8:11], a[96:99], v[208:211], v[8:11]
    buffer_load_dwordx4 v[192:195], v4, s[4:7], s64 offen offset:2048 sc1
    ds_read_b64_tr_b16 v[48:49], v22 offset:4096
    v_mfma_f32_16x16x32_bf16 v[12:15], a[100:103], v[208:211], v[12:15]
    ds_read_b64_tr_b16 v[50:51], v22 offset:6144
    ds_read_b64_tr_b16 v[52:53], v23 offset:4096
    v_mfma_f32_16x16x32_bf16 v[216:219], a[104:107], v[208:211], v[216:219]
    ds_read_b64_tr_b16 v[54:55], v23 offset:6144
    ds_read_b64_tr_b16 v[56:57], v20 offset:8192
    v_mfma_f32_16x16x32_bf16 v[220:223], a[108:111], v[208:211], v[220:223]
    ds_read_b64_tr_b16 v[58:59], v20 offset:10240
    s_waitcnt vmcnt(9)
    s_waitcnt lgkmcnt(15)
    v_mfma_f32_16x16x32_bf16 v[8:11], a[112:115], v[212:215], v[8:11]
    buffer_load_dwordx4 v[196:199], v4, s[4:7], s64 offen offset:3072 sc1
    ds_read_b64_tr_b16 v[60:61], v21 offset:8192
    v_mfma_f32_16x16x32_bf16 v[12:15], a[116:119], v[212:215], v[12:15]
    ds_read_b64_tr_b16 v[62:63], v21 offset:10240
    ds_read_b64_tr_b16 v[64:65], v22 offset:8192
    v_mfma_f32_16x16x32_bf16 v[216:219], a[120:123], v[212:215], v[216:219]
    ds_read_b64_tr_b16 v[66:67], v22 offset:10240
    ds_read_b64_tr_b16 v[68:69], v23 offset:8192
    v_mfma_f32_16x16x32_bf16 v[220:223], a[124:127], v[212:215], v[220:223]
    ds_read_b64_tr_b16 v[70:71], v23 offset:10240
    s_waitcnt vmcnt(8)
    s_waitcnt lgkmcnt(15)
    v_mfma_f32_16x16x32_bf16 v[8:11], a[160:163], v[168:171], v[8:11]
    s_add_u32 s64, s88, 20480
    buffer_load_dwordx4 v[200:203], v4, s[4:7], s64 offen offset:0 sc1
    v_mfma_f32_16x16x32_bf16 v[12:15], a[164:167], v[168:171], v[12:15]
    ds_read_b64_tr_b16 v[72:73], v20 offset:12288
    ds_read_b64_tr_b16 v[74:75], v20 offset:14336
    v_mfma_f32_16x16x32_bf16 v[216:219], a[168:171], v[168:171], v[216:219]
    ds_read_b64_tr_b16 v[76:77], v21 offset:12288
    ds_read_b64_tr_b16 v[78:79], v21 offset:14336
    v_mfma_f32_16x16x32_bf16 v[220:223], a[172:175], v[168:171], v[220:223]
    ds_read_b64_tr_b16 v[80:81], v22 offset:12288
    s_waitcnt vmcnt(8)
    s_waitcnt lgkmcnt(15)
    v_mfma_f32_16x16x32_bf16 v[8:11], a[176:179], v[172:175], v[8:11]
    buffer_load_dwordx4 v[204:207], v4, s[4:7], s64 offen offset:1024 sc1
    ds_read_b64_tr_b16 v[82:83], v22 offset:14336
    v_mfma_f32_16x16x32_bf16 v[12:15], a[180:183], v[172:175], v[12:15]
    ds_read_b64_tr_b16 v[84:85], v23 offset:12288
    ds_read_b64_tr_b16 v[86:87], v23 offset:14336
    v_mfma_f32_16x16x32_bf16 v[216:219], a[184:187], v[172:175], v[216:219]
    ds_read_b64_tr_b16 v[88:89], v20 offset:16384
    ds_read_b64_tr_b16 v[90:91], v20 offset:18432
    v_mfma_f32_16x16x32_bf16 v[220:223], a[188:191], v[172:175], v[220:223]
    ds_read_b64_tr_b16 v[92:93], v21 offset:16384
    s_waitcnt vmcnt(8)
    s_waitcnt lgkmcnt(15)
    v_mfma_f32_16x16x32_bf16 v[8:11], a[224:227], v[176:179], v[8:11]
    buffer_load_dwordx4 v[208:211], v4, s[4:7], s64 offen offset:2048 sc1
    ds_read_b64_tr_b16 v[94:95], v21 offset:18432
    v_mfma_f32_16x16x32_bf16 v[12:15], a[228:231], v[176:179], v[12:15]
    ds_read_b64_tr_b16 v[96:97], v22 offset:16384
    ds_read_b64_tr_b16 v[98:99], v22 offset:18432
    v_mfma_f32_16x16x32_bf16 v[216:219], a[232:235], v[176:179], v[216:219]
    ds_read_b64_tr_b16 v[100:101], v23 offset:16384
    ds_read_b64_tr_b16 v[102:103], v23 offset:18432
    v_mfma_f32_16x16x32_bf16 v[220:223], a[236:239], v[176:179], v[220:223]
    ds_read_b64_tr_b16 v[104:105], v20 offset:20480
    s_waitcnt vmcnt(8)
    s_waitcnt lgkmcnt(15)
    v_mfma_f32_16x16x32_bf16 v[8:11], a[240:243], v[180:183], v[8:11]
    buffer_load_dwordx4 v[212:215], v4, s[4:7], s64 offen offset:3072 sc1
    ds_read_b64_tr_b16 v[106:107], v20 offset:22528
    v_mfma_f32_16x16x32_bf16 v[12:15], a[244:247], v[180:183], v[12:15]
    ds_read_b64_tr_b16 v[108:109], v21 offset:20480
    ds_read_b64_tr_b16 v[110:111], v21 offset:22528
    v_mfma_f32_16x16x32_bf16 v[216:219], a[248:251], v[180:183], v[216:219]
    ds_read_b64_tr_b16 v[112:113], v22 offset:20480
    ds_read_b64_tr_b16 v[114:115], v22 offset:22528
    v_mfma_f32_16x16x32_bf16 v[220:223], a[252:255], v[180:183], v[220:223]
    ds_read_b64_tr_b16 v[116:117], v23 offset:20480
    s_waitcnt vmcnt(8)
    s_waitcnt lgkmcnt(15)
    v_mfma_f32_16x16x32_bf16 v[8:11], v[24:27], v[184:187], v[8:11]
    buffer_load_dwordx2 v[168:169], v7, s[4:7], s89 offen offset:3072 sc1
    buffer_load_dwordx2 v[170:171], v7, s[4:7], s89 offen offset:3584 sc1
    v_mfma_f32_16x16x32_bf16 v[12:15], v[28:31], v[184:187], v[12:15]
    ds_read_b64_tr_b16 v[118:119], v23 offset:22528
    ds_read_b64_tr_b16 v[120:121], v20 offset:24576
    v_mfma_f32_16x16x32_bf16 v[216:219], v[32:35], v[184:187], v[216:219]
    ds_read_b64_tr_b16 v[122:123], v20 offset:26624
    ds_read_b64_tr_b16 v[124:125], v21 offset:24576
    v_mfma_f32_16x16x32_bf16 v[220:223], v[36:39], v[184:187], v[220:223]
    ds_read_b64_tr_b16 v[126:127], v21 offset:26624
    s_waitcnt vmcnt(8)
    s_waitcnt lgkmcnt(15)
    v_mfma_f32_16x16x32_bf16 v[8:11], v[40:43], v[188:191], v[8:11]
    s_add_u32 s64, s88, 24576
    buffer_load_dwordx4 v[172:175], v4, s[4:7], s64 offen offset:1024 sc1
    v_mfma_f32_16x16x32_bf16 v[12:15], v[44:47], v[188:191], v[12:15]
    ds_read_b64_tr_b16 v[128:129], v22 offset:24576
    ds_read_b64_tr_b16 v[130:131], v22 offset:26624
    v_mfma_f32_16x16x32_bf16 v[216:219], v[48:51], v[188:191], v[216:219]
    ds_read_b64_tr_b16 v[132:133], v23 offset:24576
    ds_read_b64_tr_b16 v[134:135], v23 offset:26624
    v_mfma_f32_16x16x32_bf16 v[220:223], v[52:55], v[188:191], v[220:223]
    ds_read_b64_tr_b16 v[136:137], v20 offset:28672
    s_waitcnt vmcnt(8)
    s_waitcnt lgkmcnt(15)
    v_mfma_f32_16x16x32_bf16 v[8:11], v[56:59], v[192:195], v[8:11]
    buffer_load_dwordx4 v[176:179], v4, s[4:7], s64 offen offset:2048 sc1
    ds_read_b64_tr_b16 v[138:139], v20 offset:30720
    v_mfma_f32_16x16x32_bf16 v[12:15], v[60:63], v[192:195], v[12:15]
    ds_read_b64_tr_b16 v[140:141], v21 offset:28672
    ds_read_b64_tr_b16 v[142:143], v21 offset:30720
    v_mfma_f32_16x16x32_bf16 v[216:219], v[64:67], v[192:195], v[216:219]
    ds_read_b64_tr_b16 v[144:145], v22 offset:28672
    ds_read_b64_tr_b16 v[146:147], v22 offset:30720
    v_mfma_f32_16x16x32_bf16 v[220:223], v[68:71], v[192:195], v[220:223]
    ds_read_b64_tr_b16 v[148:149], v23 offset:28672
    s_waitcnt vmcnt(8)
    s_waitcnt lgkmcnt(15)
    v_mfma_f32_16x16x32_bf16 v[8:11], v[72:75], v[196:199], v[8:11]
    buffer_load_dwordx4 v[180:183], v4, s[4:7], s64 offen offset:3072 sc1
    ds_read_b64_tr_b16 v[150:151], v23 offset:30720
    v_mfma_f32_16x16x32_bf16 v[12:15], v[76:79], v[196:199], v[12:15]
    ds_read_b64_tr_b16 v[152:153], v20 offset:32768
    ds_read_b64_tr_b16 v[154:155], v20 offset:34816
    v_mfma_f32_16x16x32_bf16 v[216:219], v[80:83], v[196:199], v[216:219]
    ds_read_b64_tr_b16 v[156:157], v21 offset:32768
    ds_read_b64_tr_b16 v[158:159], v21 offset:34816
    v_mfma_f32_16x16x32_bf16 v[220:223], v[84:87], v[196:199], v[220:223]
    ds_read_b64_tr_b16 v[160:161], v22 offset:32768
    s_waitcnt vmcnt(8)
    s_waitcnt lgkmcnt(15)
    v_mfma_f32_16x16x32_bf16 v[8:11], v[88:91], v[200:203], v[8:11]
    ds_read_b64_tr_b16 v[162:163], v22 offset:34816
    ds_read_b64_tr_b16 v[164:165], v23 offset:32768
    v_mfma_f32_16x16x32_bf16 v[12:15], v[92:95], v[200:203], v[12:15]
    ds_read_b64_tr_b16 v[166:167], v23 offset:34816
    ds_read_b64_tr_b16 v[24:25], v20 offset:36864
    v_mfma_f32_16x16x32_bf16 v[216:219], v[96:99], v[200:203], v[216:219]
    ds_read_b64_tr_b16 v[26:27], v20 offset:38912
    ds_read_b64_tr_b16 v[28:29], v21 offset:36864
    v_mfma_f32_16x16x32_bf16 v[220:223], v[100:103], v[200:203], v[220:223]
    ds_read_b64_tr_b16 v[30:31], v21 offset:38912
    s_waitcnt vmcnt(7)
    s_waitcnt lgkmcnt(15)
    v_mfma_f32_16x16x32_bf16 v[8:11], v[104:107], v[204:207], v[8:11]
    ds_read_b64_tr_b16 v[32:33], v22 offset:36864
    ds_read_b64_tr_b16 v[34:35], v22 offset:38912
    v_mfma_f32_16x16x32_bf16 v[12:15], v[108:111], v[204:207], v[12:15]
    ds_read_b64_tr_b16 v[36:37], v23 offset:36864
    ds_read_b64_tr_b16 v[38:39], v23 offset:38912
    v_mfma_f32_16x16x32_bf16 v[216:219], v[112:115], v[204:207], v[216:219]
    ds_read_b64_tr_b16 v[40:41], v20 offset:40960
    ds_read_b64_tr_b16 v[42:43], v20 offset:43008
    v_mfma_f32_16x16x32_bf16 v[220:223], v[116:119], v[204:207], v[220:223]
    ds_read_b64_tr_b16 v[44:45], v21 offset:40960
    s_waitcnt vmcnt(6)
    s_waitcnt lgkmcnt(15)
    v_mfma_f32_16x16x32_bf16 v[8:11], v[120:123], v[208:211], v[8:11]
    ds_read_b64_tr_b16 v[46:47], v21 offset:43008
    ds_read_b64_tr_b16 v[48:49], v22 offset:40960
    v_mfma_f32_16x16x32_bf16 v[12:15], v[124:127], v[208:211], v[12:15]
    ds_read_b64_tr_b16 v[50:51], v22 offset:43008
    ds_read_b64_tr_b16 v[52:53], v23 offset:40960
    v_mfma_f32_16x16x32_bf16 v[216:219], v[128:131], v[208:211], v[216:219]
    ds_read_b64_tr_b16 v[54:55], v23 offset:43008
    ds_read_b64_tr_b16 v[56:57], v20 offset:45056
    v_mfma_f32_16x16x32_bf16 v[220:223], v[132:135], v[208:211], v[220:223]
    ds_read_b64_tr_b16 v[58:59], v20 offset:47104
    s_waitcnt vmcnt(5)
    s_waitcnt lgkmcnt(15)
    v_mfma_f32_16x16x32_bf16 v[8:11], v[136:139], v[212:215], v[8:11]
    ds_read_b64_tr_b16 v[60:61], v21 offset:45056
    ds_read_b64_tr_b16 v[62:63], v21 offset:47104
    v_mfma_f32_16x16x32_bf16 v[12:15], v[140:143], v[212:215], v[12:15]
    ds_read_b64_tr_b16 v[64:65], v22 offset:45056
    ds_read_b64_tr_b16 v[66:67], v22 offset:47104
    v_mfma_f32_16x16x32_bf16 v[216:219], v[144:147], v[212:215], v[216:219]
    ds_read_b64_tr_b16 v[68:69], v23 offset:45056
    ds_read_b64_tr_b16 v[70:71], v23 offset:47104
    v_mfma_f32_16x16x32_bf16 v[220:223], v[148:151], v[212:215], v[220:223]
    v_lshlrev_b32_e64 v224, 16, v240
    s_waitcnt vmcnt(3)
    s_waitcnt lgkmcnt(15)
    v_mfma_f32_16x16x32_bf16 v[8:11], v[152:155], v[168:171], v[8:11]
    v_and_b32 v225, 0xffff0000, v240
    v_lshlrev_b32_e64 v226, 16, v241
    v_mfma_f32_16x16x32_bf16 v[12:15], v[156:159], v[168:171], v[12:15]
    v_and_b32 v227, 0xffff0000, v241
    v_lshlrev_b32_e64 v228, 16, v242
    v_mfma_f32_16x16x32_bf16 v[216:219], v[160:163], v[168:171], v[216:219]
    v_and_b32 v229, 0xffff0000, v242
    v_lshlrev_b32_e64 v230, 16, v243
    v_mfma_f32_16x16x32_bf16 v[220:223], v[164:167], v[168:171], v[220:223]
    v_and_b32 v231, 0xffff0000, v243
    s_waitcnt vmcnt(2)
    s_waitcnt lgkmcnt(15)
    v_mfma_f32_16x16x32_bf16 v[8:11], v[24:27], v[172:175], v[8:11]
    v_lshlrev_b32_e64 v232, 16, v244
    v_and_b32 v233, 0xffff0000, v244
    v_mfma_f32_16x16x32_bf16 v[12:15], v[28:31], v[172:175], v[12:15]
    v_lshlrev_b32_e64 v234, 16, v245
    v_and_b32 v235, 0xffff0000, v245
    v_mfma_f32_16x16x32_bf16 v[216:219], v[32:35], v[172:175], v[216:219]
    v_lshlrev_b32_e64 v236, 16, v246
    v_and_b32 v237, 0xffff0000, v246
    v_mfma_f32_16x16x32_bf16 v[220:223], v[36:39], v[172:175], v[220:223]
    v_lshlrev_b32_e64 v238, 16, v247
    s_waitcnt vmcnt(1)
    s_waitcnt lgkmcnt(8)
    v_mfma_f32_16x16x32_bf16 v[8:11], v[40:43], v[176:179], v[8:11]
    v_and_b32 v239, 0xffff0000, v247
    v_lshlrev_b32_e64 v72, 16, v248
    v_mfma_f32_16x16x32_bf16 v[12:15], v[44:47], v[176:179], v[12:15]
    v_and_b32 v73, 0xffff0000, v248
    v_lshlrev_b32_e64 v74, 16, v249
    v_mfma_f32_16x16x32_bf16 v[216:219], v[48:51], v[176:179], v[216:219]
    v_and_b32 v75, 0xffff0000, v249
    v_lshlrev_b32_e64 v76, 16, v250
    v_mfma_f32_16x16x32_bf16 v[220:223], v[52:55], v[176:179], v[220:223]
    v_and_b32 v77, 0xffff0000, v250
    s_waitcnt vmcnt(0)
    s_waitcnt lgkmcnt(0)
    v_mfma_f32_16x16x32_bf16 v[8:11], v[56:59], v[180:183], v[8:11]
    v_lshlrev_b32_e64 v78, 16, v251
    v_and_b32 v79, 0xffff0000, v251
    v_mfma_f32_16x16x32_bf16 v[12:15], v[60:63], v[180:183], v[12:15]
    v_lshlrev_b32_e64 v80, 16, v252
    v_and_b32 v81, 0xffff0000, v252
    v_mfma_f32_16x16x32_bf16 v[216:219], v[64:67], v[180:183], v[216:219]
    v_lshlrev_b32_e64 v82, 16, v253
    v_and_b32 v83, 0xffff0000, v253
    v_mfma_f32_16x16x32_bf16 v[220:223], v[68:71], v[180:183], v[220:223]
    v_lshlrev_b32_e64 v84, 16, v254
    v_and_b32 v85, 0xffff0000, v254
    v_lshlrev_b32_e64 v86, 16, v255
    v_and_b32 v87, 0xffff0000, v255
    v_cmp_u_f32 vcc, v8, v8
    s_nop 0
    s_cbranch_vccnz L_p5redo
L_p5ok:
    s_nop 0
    v_pk_fma_f32 v[224:225], v[72:73], v[8:9], v[224:225]
    v_pk_fma_f32 v[226:227], v[74:75], v[10:11], v[226:227]
    v_cvt_pk_bf16_f32 v24, v224, v225
    v_cvt_pk_bf16_f32 v25, v226, v227
    v_pk_fma_f32 v[228:229], v[76:77], v[12:13], v[228:229]
    v_pk_fma_f32 v[230:231], v[78:79], v[14:15], v[230:231]
    v_cvt_pk_bf16_f32 v26, v228, v229
    v_cvt_pk_bf16_f32 v27, v230, v231
    v_pk_fma_f32 v[232:233], v[80:81], v[216:217], v[232:233]
    v_pk_fma_f32 v[234:235], v[82:83], v[218:219], v[234:235]
    v_cvt_pk_bf16_f32 v28, v232, v233
    v_cvt_pk_bf16_f32 v29, v234, v235
    v_pk_fma_f32 v[236:237], v[84:85], v[220:221], v[236:237]
    v_pk_fma_f32 v[238:239], v[86:87], v[222:223], v[238:239]
    v_cvt_pk_bf16_f32 v30, v236, v237
    v_cvt_pk_bf16_f32 v31, v238, v239
    v_permlane16_swap_b32 v24, v26
    v_permlane16_swap_b32 v25, v27
    v_permlane16_swap_b32 v28, v30
    v_permlane16_swap_b32 v29, v31
    v_mov_b32 v32, v24
    v_mov_b32 v33, v25
    v_mov_b32 v34, v26
    v_mov_b32 v35, v27
    v_mov_b32_dpp v24, v28 row_ror:8 row_mask:0xf bank_mask:0xc
    v_mov_b32_dpp v25, v29 row_ror:8 row_mask:0xf bank_mask:0xc
    v_mov_b32_dpp v26, v30 row_ror:8 row_mask:0xf bank_mask:0xc
    v_mov_b32_dpp v27, v31 row_ror:8 row_mask:0xf bank_mask:0xc
    buffer_store_dwordx4 v[24:27], v5, s[28:31], s91 offen sc1
    v_mov_b32_dpp v28, v32 row_ror:8 row_mask:0xf bank_mask:0x3
    v_mov_b32_dpp v29, v33 row_ror:8 row_mask:0xf bank_mask:0x3
    v_mov_b32_dpp v30, v34 row_ror:8 row_mask:0xf bank_mask:0x3
    v_mov_b32_dpp v31, v35 row_ror:8 row_mask:0xf bank_mask:0x3
    buffer_store_dwordx4 v[28:31], v6, s[28:31], s91 offen sc1
    s_endpgm
L_zero:
    s_mov_b32 s6, 0x2000000
    s_mov_b32 s7, 0x20000
    s_lshl_b32 s66, s2, 10
    v_mov_b32 v28, 0
    v_mov_b32 v29, 0
    v_mov_b32 v30, 0
    v_mov_b32 v31, 0
    buffer_store_dwordx4 v[28:31], v4, s[4:7], s66 offen sc1
    s_branch L_zeroj
ga_23:
    s_add_u32 s54, s54, 1
    s_cmp_ge_u32 s54, 0x40000
    s_cbranch_scc1 gax_24
    buffer_load_dwordx2 v[210:211], v206, s[4:7], s94 offen offset:0 sc1
    buffer_load_dwordx2 v[212:213], v206, s[4:7], s94 offen offset:512 sc1
    buffer_load_dwordx2 v[214:215], v206, s[4:7], s94 offen offset:1024 sc1
    buffer_load_dwordx2 v[216:217], v206, s[4:7], s94 offen offset:1536 sc1
    buffer_load_dwordx2 v[218:219], v206, s[4:7], s94 offen offset:2048 sc1
    buffer_load_dwordx2 v[220:221], v206, s[4:7], s94 offen offset:2560 sc1
    buffer_load_dwordx2 v[222:223], v206, s[4:7], s94 offen offset:3072 sc1
    buffer_load_dwordx2 v[224:225], v206, s[4:7], s94 offen offset:3584 sc1
    s_waitcnt vmcnt(0)
    s_branch gac_25
ga_27:
    s_add_u32 s54, s54, 1
    s_cmp_ge_u32 s54, 0x40000
    s_cbranch_scc1 gax_28
    buffer_load_dwordx2 v[210:211], v206, s[4:7], s60 offen offset:0 sc1
    buffer_load_dwordx2 v[212:213], v206, s[4:7], s60 offen offset:512 sc1
    buffer_load_dwordx2 v[214:215], v206, s[4:7], s60 offen offset:1024 sc1
    buffer_load_dwordx2 v[216:217], v206, s[4:7], s60 offen offset:1536 sc1
    buffer_load_dwordx2 v[218:219], v206, s[4:7], s60 offen offset:2048 sc1
    buffer_load_dwordx2 v[220:221], v206, s[4:7], s60 offen offset:2560 sc1
    buffer_load_dwordx2 v[222:223], v206, s[4:7], s60 offen offset:3072 sc1
    buffer_load_dwordx2 v[224:225], v206, s[4:7], s60 offen offset:3584 sc1
    s_waitcnt vmcnt(0)
    s_branch gac_29
L_p5redo:
    s_add_u32 s54, s54, 1
    s_cmp_gt_u32 s54, 64
    s_cbranch_scc1 L_p5ok
    s_add_u32 s64, s88, 0
    buffer_load_dwordx4 v[168:171], v4, s[4:7], s64 offen offset:0 sc1
    buffer_load_dwordx4 v[172:175], v4, s[4:7], s64 offen offset:1024 sc1
    s_add_u32 s64, s88, 4096
    buffer_load_dwordx4 v[176:179], v4, s[4:7], s64 offen offset:0 sc1
    buffer_load_dwordx4 v[180:183], v4, s[4:7], s64 offen offset:1024 sc1
    s_add_u32 s64, s88, 8192
    buffer_load_dwordx4 v[184:187], v4, s[4:7], s64 offen offset:0 sc1
    buffer_load_dwordx4 v[188:191], v4, s[4:7], s64 offen offset:1024 sc1
    s_add_u32 s64, s88, 12288
    buffer_load_dwordx4 v[192:195], v4, s[4:7], s64 offen offset:0 sc1
    buffer_load_dwordx4 v[196:199], v4, s[4:7], s64 offen offset:1024 sc1
    s_branch L_p5
L_END:
    s_endpgm
.section .rodata,"a"
.p2align 6
.amdhsa_kernel adaLN_cond__ssm_conv_s4d__mixer_gmlp__prompt_kernel
  .amdhsa_next_free_vgpr 512
  .amdhsa_next_free_sgpr 102
  .amdhsa_accum_offset 256
  .amdhsa_group_segment_fixed_size 0
  .amdhsa_kernarg_size 136
  .amdhsa_user_sgpr_count 2
  .amdhsa_user_sgpr_kernarg_segment_ptr 1
  .amdhsa_system_sgpr_workgroup_id_x 1
.end_amdhsa_kernel
```
